```python
import torch

def _softmax(x, axis=-1):
    return torch.softmax(x, dim=axis)
def _gelu(x):
    return torch.nn.functional.gelu(x, approximate="tanh")
def _silu(x):
    return torch.nn.functional.silu(x)
def _sigmoid(x):
    return torch.sigmoid(x)
def _layernorm(x, axis=-1, eps=1e-5):
    m = x.mean(dim=axis, keepdim=True)
    v = x.var(dim=axis, keepdim=True, unbiased=False)
    return (x - m) / torch.sqrt(v + eps)
def _scatter_add(tgt, idx, src, axis=0):
    return tgt.clone().index_add_(axis, idx, src)
def _segment_sum(src, seg, n):
    out = torch.zeros((n,) + src.shape[1:], dtype=src.dtype)
    return out.index_add_(0, seg, src)
def _pad(x, pw):
    flat = tuple(v for pair in reversed(pw) for v in pair)
    return torch.nn.functional.pad(x, flat)

kernel_name = 'interleave_layers__ssm_conv_s4d__linear_attn_block__prompt'

def setup_inputs():

    _w = (lambda a: (lambda t: t.to(torch.bfloat16) if t.is_floating_point() else t)(torch.as_tensor(a)))
    def _A_setup():
        Bsz, L, D, N = 1, 2048, 512, 128
        return {
            "u": _w((lambda *s: torch.randn(*s, dtype=torch.bfloat16) * 0.05)(Bsz, L, D)),
            "log_A_real": _w((lambda *s: torch.randn(*s, dtype=torch.bfloat16) * 1.6)(D, N) * 0.5),
            "A_imag": _w((lambda *s: torch.randn(*s, dtype=torch.bfloat16) * 0.05)(D, N) * 3.14),
            "C_real": _w((lambda *s: torch.randn(*s, dtype=torch.bfloat16) * 0.05)(D, N) / N ** 0.5),
            "C_imag": _w((lambda *s: torch.randn(*s, dtype=torch.bfloat16) * 0.05)(D, N) / N ** 0.5),
            "log_dt": _w((lambda *s: torch.randn(*s, dtype=torch.bfloat16) * 0.05)(D) * 0.5 - 4.0),
            "D_skip": _w((lambda *s: torch.randn(*s, dtype=torch.bfloat16) * 0.05)(D)),
        }
    _A_in = _A_setup()

    def _B_setup():
        B, S, D = 1, 2048, 512
        return {
            "x": _w((lambda *s: torch.randn(*s, dtype=torch.bfloat16) * 0.05)(B, S, D)),
            "wqkv": _w((lambda *s: torch.randn(*s, dtype=torch.bfloat16) * 0.05)(D, 3 * D)),
            "wo": _w((lambda *s: torch.randn(*s, dtype=torch.bfloat16) * 0.05)(D, D)),
        }
    _B_in = _B_setup()

    return {
        "A_u": _A_in["u"],
        "A_log_A_real": _A_in["log_A_real"],
        "A_A_imag": _A_in["A_imag"],
        "A_C_real": _A_in["C_real"],
        "A_C_imag": _A_in["C_imag"],
        "A_log_dt": _A_in["log_dt"],
        "A_D_skip": _A_in["D_skip"],
        "B_x": _B_in["x"],
        "B_wqkv": _B_in["wqkv"],
        "B_wo": _B_in["wo"],
    }

def reference(A_u, A_log_A_real, A_A_imag, A_C_real, A_C_imag, A_log_dt, A_D_skip, B_x, B_wqkv, B_wo):
    def _A_ref(u, log_A_real, A_imag, C_real, C_imag, log_dt, D_skip):
        L = u.shape[1]
        dt = torch.exp(log_dt)
        A = -torch.exp(log_A_real) + 1j * A_imag
        C = (C_real + 1j * C_imag) * dt[:, None]
        pos = (lambda x, dt: x.to(dt))(torch.arange(L), log_dt.dtype)
        P = torch.exp((A * dt[:, None])[:, :, None] * pos[None, None, :])
        K = 2.0 * torch.einsum("dn,dnl->dl", C, P).real
        L2 = 2 * L
        u_t = (lambda x, *d: x.permute(*d))(u, 0, 2, 1)
        Kf = (lambda x, *a, **k: torch.fft.rfft(x.float(), *a, **k))(K, L2)
        Uf = (lambda x, *a, **k: torch.fft.rfft(x.float(), *a, **k))(u_t, L2)
        y = (lambda x, *a, **k: torch.fft.irfft(x, *a, **k).to(torch.bfloat16))(Uf * Kf[None, :, :], L2)[:, :, :L]
        y = (lambda x, *d: x.permute(*d))(y, 0, 2, 1)
        return y + u * D_skip[None, None, :]

    def _B_ref(x, wqkv, wo):
        B, S, D = x.shape
        H = 32; Dh = D // H
        qkv = (lambda x, *d: x.permute(*d))((x @ wqkv).reshape(B, S, 3, H, Dh), 2, 0, 3, 1, 4)
        q, k, v = qkv[0], qkv[1], qkv[2]
        phi = lambda t: torch.where(t > 0, t + 1, torch.exp(t)) + 1e-6
        pq, pk = phi(q), phi(k)
        kv = torch.einsum("bhsd,bhse->bhde", pk, v)
        z = torch.einsum("bhsd->bhd", pk)
        num = torch.einsum("bhqd,bhde->bhqe", pq, kv)
        den = torch.einsum("bhqd,bhd->bhq", pq, z)[..., None] + 1e-6
        o = num / den
        return (lambda x, *d: x.permute(*d))(o, 0, 2, 1, 3).reshape(B, S, D) @ wo

    x = A_u
    x = x + _A_ref(_layernorm(x, axis=-1), A_log_A_real, A_A_imag, A_C_real, A_C_imag, A_log_dt, A_D_skip)
    x = x + _B_ref(_layernorm(x, axis=-1), B_wqkv, B_wo)
    x = x + _A_ref(_layernorm(x, axis=-1), A_log_A_real, A_A_imag, A_C_real, A_C_imag, A_log_dt, A_D_skip)
    x = x + _B_ref(_layernorm(x, axis=-1), B_wqkv, B_wo)
    return x
```

```asm
; @launch grid=(256,1,1) block=(256,1,1) lds=163840
.amdgcn_target "amdgcn-amd-amdhsa--gfx950"
.text
.globl interleave_layers__ssm_conv_s4d__linear_attn_block__prompt_kernel
.p2align 8
.type interleave_layers__ssm_conv_s4d__linear_attn_block__prompt_kernel,@function
interleave_layers__ssm_conv_s4d__linear_attn_block__prompt_kernel:
  s_cmp_ge_u32 s2, 256
  s_cbranch_scc1 L_EXIT
  s_getpc_b64 s[66:67]
  s_load_dwordx16 s[16:31], s[0:1], 0
  s_load_dwordx8 s[32:39], s[0:1], 64
  s_load_dwordx2 s[40:41], s[0:1], 96
  v_lshlrev_b32_e64 v198, 7, v0
  global_load_dword v198, v198, s[66:67]
  v_and_b32 v255, 63, v0
  v_lshrrev_b32 v1, 6, v0
  v_and_b32_e64 v243, 15, v0
  v_bfe_u32 v242, v0, 4, 2
  v_readfirstlane_b32 s3, v1
  s_and_b32 s8, s2, 7
  s_lshl_b32 s8, s8, 2
  s_lshr_b32 s9, s2, 6
  s_add_u32 s4, s8, s9
  s_lshr_b32 s5, s2, 3
  s_and_b32 s5, s5, 7
  s_mov_b32 s6, 0
  s_mov_b32 s7, 0
  s_mov_b32 s64, 0x3f803f80
  v_mov_b32 v237, 1
  s_and_b32 s8, s2, 15
  s_lshl_b32 s8, s8, 10
  v_mov_b32 v239, s8
  v_lshlrev_b32 v238, 10, v255
  v_add_u32 v238, 0, v238
  v_lshrrev_b32 v1, 3, v0
  s_lshl_b32 s8, s4, 16
  s_lshl_b32 s9, s5, 7
  s_add_u32 s8, s8, s9
  v_lshlrev_b32 v2, 10, v1
  v_and_b32_e64 v3, 7, v0
  v_lshl_add_u32 v2, v3, 4, v2
  v_add_u32_e64 v2, s8, v2
  v_add_u32 v4, 0x8000, v2
  s_and_b32 s8, s2, 63
  s_lshl_b32 s8, s8, 2
  s_add_u32 s8, s8, s3
  s_lshl_b32 s8, s8, 3
  s_lshr_b32 s9, s2, 6
  s_lshl_b32 s9, s9, 1
  s_add_u32 s8, s8, s9
  s_lshl_b32 s8, s8, 10
  v_lshlrev_b32 v5, 4, v255
  v_add_u32 v5, s8, v5
  s_lshl_b32 s8, s2, 9
  v_lshlrev_b32 v6, 1, v0
  v_add_u32 v6, s8, v6
  v_lshrrev_b32_e64 v7, 7, v0
  s_lshl_b32 s8, s2, 1
  v_add_lshl_u32 v7, v7, s8, 1
  s_lshl_b32 s8, s2, 2
  v_mov_b32_e64 v9, s8
  s_and_b32 s10, s2, 7
  s_cmp_lt_u32 s2, 192
  s_cbranch_scc0 WT_1
  s_lshr_b32 s11, s2, 3
  s_mul_i32 s8, s10, 196608
  s_lshl_b32 s9, s11, 7
  s_add_u32 s8, s8, s9
  v_mul_u32_u24 v8, 3072, v1
  v_lshl_add_u32 v8, v3, 4, v8
  v_add_u32_e64 v8, s8, v8
  v_add_u32 v31, 98304, v8
  s_branch WT_2
WT_1:
  s_sub_u32 s11, s2, 192
  s_lshr_b32 s11, s11, 3
  s_lshl_b32 s8, s10, 16
  s_lshl_b32 s9, s11, 7
  s_add_u32 s8, s8, s9
  v_lshlrev_b32 v8, 10, v1
  v_lshl_add_u32 v8, v3, 4, v8
  v_add_u32_e64 v8, s8, v8
  v_add_u32 v31, 0x8000, v8
WT_2:
  s_cmp_lt_u32 s2, 192
  s_waitcnt lgkmcnt(0)
  s_cselect_b32 s68, s32, s34
  s_cselect_b32 s69, s33, s35
  s_nop 0
  global_load_dwordx4 v[10:13], v2, s[16:17]
  global_load_dwordx4 v[14:17], v4, s[16:17]
  global_load_dwordx4 v[18:21], v5, s[16:17]
  global_load_dwordx4 v[22:25], v5, s[16:17] offset:1024
  global_load_ushort v26, v6, s[18:19]
  global_load_ushort v27, v6, s[20:21]
  global_load_ushort v28, v6, s[22:23]
  global_load_ushort v29, v6, s[24:25]
  global_load_ushort v30, v7, s[26:27]
  global_load_dword v244, v9, s[28:29]
  global_load_dwordx4 v[200:203], v8, s[68:69]
  global_load_dwordx4 v[204:207], v31, s[68:69]
  s_mov_b32 s44, s40
  s_and_b32 s45, s41, 0xffff
  s_mov_b32 s46, 15728640
  s_mov_b32 s47, 0x20000
  s_mov_b32 s48, s32
  s_and_b32 s49, s33, 0xffff
  s_mov_b32 s50, 1572864
  s_mov_b32 s51, 0x20000
  s_mov_b32 s52, s34
  s_and_b32 s53, s35, 0xffff
  s_mov_b32 s54, 524288
  s_mov_b32 s55, 0x20000
  s_mov_b32 s56, s36
  s_and_b32 s57, s37, 0xffff
  s_mov_b32 s58, 2097152
  s_mov_b32 s59, 0x20000
  s_lshl_b32 s8, s4, 10
  s_add_u32 s8, s8, 131072
  v_mov_b32 v235, s8
  v_cmp_eq_u32 vcc, 16, v255
  s_nop 1
  v_cndmask_b32 v234, v238, v235, vcc
  s_cmp_lt_u32 s2, 16
  s_cbranch_scc0 CI_3
  s_cmp_eq_u32 s3, 0
  s_cbranch_scc0 CI_3
  s_mov_b64 exec, 1
  v_mov_b32_e64 v8, 0
  buffer_store_dword v8, v239, s[44:47], 0 offen sc1
  v_add_u32 v9, 147456, v239
  buffer_store_dword v8, v9, s[44:47], 0 offen sc1
  s_mov_b64 exec, -1
CI_3:
  v_lshlrev_b32 v31, 3, v0
  v_sub_u32 v31, 2047, v31
  s_mov_b32 s13, 111104
  v_subrev_u32 v32, 0, v31
  v_subrev_u32 v36, 2, v31
  v_subrev_u32 v40, 4, v31
  v_subrev_u32 v44, 6, v31
  v_subrev_u32 v48, 8, v31
  v_subrev_u32 v33, 1, v31
  v_subrev_u32 v37, 3, v31
  v_subrev_u32 v41, 5, v31
  v_subrev_u32 v45, 7, v31
  v_subrev_u32 v49, 9, v31
  v_max_i32 v32, 0, v32
  v_max_i32 v36, 0, v36
  v_max_i32 v40, 0, v40
  v_max_i32 v44, 0, v44
  v_max_i32 v48, 0, v48
  v_max_i32 v33, 0, v33
  v_max_i32 v37, 0, v37
  v_max_i32 v41, 0, v41
  v_max_i32 v45, 0, v45
  v_max_i32 v49, 0, v49
  v_cvt_f32_i32 v32, v32
  v_cvt_f32_i32 v36, v36
  v_cvt_f32_i32 v40, v40
  v_cvt_f32_i32 v44, v44
  v_cvt_f32_i32 v48, v48
  v_cvt_f32_i32 v33, v33
  v_cvt_f32_i32 v37, v37
  v_cvt_f32_i32 v41, v41
  v_cvt_f32_i32 v45, v45
  v_cvt_f32_i32 v49, v49
  v_cvt_pk_bf16_f32 v34, v32, v33
  v_cvt_pk_bf16_f32 v38, v36, v37
  v_cvt_pk_bf16_f32 v42, v40, v41
  v_cvt_pk_bf16_f32 v46, v44, v45
  v_cvt_pk_bf16_f32 v50, v48, v49
  v_lshlrev_b32 v32, 16, v34
  v_lshlrev_b32 v36, 16, v38
  v_lshlrev_b32 v40, 16, v42
  v_lshlrev_b32 v44, 16, v46
  v_lshlrev_b32_e64 v48, 16, v50
  v_and_b32 v33, 0xffff0000, v34
  v_and_b32 v37, 0xffff0000, v38
  v_and_b32 v41, 0xffff0000, v42
  v_and_b32 v45, 0xffff0000, v46
  v_and_b32 v49, 0xffff0000, v50
  v_cvt_u32_f32 v32, v32
  v_cvt_u32_f32 v36, v36
  v_cvt_u32_f32 v40, v40
  v_cvt_u32_f32 v44, v44
  v_cvt_u32_f32 v48, v48
  v_cvt_u32_f32 v33, v33
  v_cvt_u32_f32 v37, v37
  v_cvt_u32_f32 v41, v41
  v_cvt_u32_f32 v45, v45
  v_cvt_u32_f32 v49, v49
  v_lshrrev_b32 v34, 2, v32
  v_lshrrev_b32 v38, 2, v36
  v_lshrrev_b32 v42, 2, v40
  v_lshrrev_b32 v46, 2, v44
  v_lshrrev_b32 v50, 2, v48
  v_lshrrev_b32 v35, 2, v33
  v_lshrrev_b32 v39, 2, v37
  v_lshrrev_b32 v43, 2, v41
  v_lshrrev_b32 v47, 2, v45
  v_lshrrev_b32 v51, 2, v49
  v_add_u32 v34, 384, v34
  v_add_u32 v38, 384, v38
  v_add_u32 v42, 384, v42
  v_add_u32 v46, 384, v46
  v_add_u32 v50, 384, v50
  v_add_u32 v35, 384, v35
  v_add_u32 v39, 384, v39
  v_add_u32 v43, 384, v43
  v_add_u32 v47, 384, v47
  v_add_u32 v51, 384, v51
  v_min_u32 v32, v32, v34
  v_min_u32 v36, v36, v38
  v_min_u32 v40, v40, v42
  v_min_u32 v44, v44, v46
  v_min_u32 v48, v48, v50
  v_min_u32 v33, v33, v35
  v_min_u32 v37, v37, v39
  v_min_u32 v41, v41, v43
  v_min_u32 v45, v45, v47
  v_min_u32 v49, v49, v51
  v_lshrrev_b32 v34, 5, v32
  v_lshrrev_b32 v38, 5, v36
  v_lshrrev_b32 v42, 5, v40
  v_lshrrev_b32 v46, 5, v44
  v_lshrrev_b32 v50, 5, v48
  v_lshrrev_b32 v35, 5, v33
  v_lshrrev_b32 v39, 5, v37
  v_lshrrev_b32 v43, 5, v41
  v_lshrrev_b32 v47, 5, v45
  v_lshrrev_b32 v51, 5, v49
  v_add_u32 v32, v32, v34
  v_add_u32 v36, v36, v38
  v_add_u32 v40, v40, v42
  v_add_u32 v44, v44, v46
  v_add_u32 v48, v48, v50
  v_add_u32 v33, v33, v35
  v_add_u32 v37, v37, v39
  v_add_u32 v41, v41, v43
  v_add_u32 v45, v45, v47
  v_add_u32 v49, v49, v51
  v_lshl_add_u32 v180, v32, 2, s13
  v_lshl_add_u32 v182, v36, 2, s13
  v_lshl_add_u32 v184, v40, 2, s13
  v_lshl_add_u32 v186, v44, 2, s13
  v_lshl_add_u32 v188, v48, 2, s13
  v_lshl_add_u32 v181, v33, 2, s13
  v_lshl_add_u32 v183, v37, 2, s13
  v_lshl_add_u32 v185, v41, 2, s13
  v_lshl_add_u32 v187, v45, 2, s13
  v_mul_u32_u24 v8, 144, v1
  v_lshl_add_u32 v8, v3, 4, v8
  v_add_u32 v9, 128512, v8
  v_add_u32 v8, 82432, v8
  s_waitcnt vmcnt(10)
  ds_write_b128 v8, v[10:13]
  ds_write_b128 v8, v[14:17] offset:4608
  s_waitcnt vmcnt(8)
  v_mov_b32 v32, 0
  v_mov_b32 v33, 0
  v_mov_b32 v34, 0
  v_mov_b32 v35, 0
  v_dot2_f32_bf16 v32, v18, s64, v32
  v_dot2_f32_bf16 v33, v18, v18, v33
  v_dot2_f32_bf16 v34, v22, s64, v34
  v_dot2_f32_bf16 v35, v22, v22, v35
  v_dot2_f32_bf16 v32, v19, s64, v32
  v_dot2_f32_bf16 v33, v19, v19, v33
  v_dot2_f32_bf16 v34, v23, s64, v34
  v_dot2_f32_bf16 v35, v23, v23, v35
  v_dot2_f32_bf16 v32, v20, s64, v32
  v_dot2_f32_bf16 v33, v20, v20, v33
  v_dot2_f32_bf16 v34, v24, s64, v34
  v_dot2_f32_bf16 v35, v24, v24, v35
  v_dot2_f32_bf16 v32, v21, s64, v32
  v_dot2_f32_bf16 v33, v21, v21, v33
  v_dot2_f32_bf16 v34, v25, s64, v34
  v_dot2_f32_bf16 v35, v25, v25, v35
  v_add_f32_dpp v32, v32, v32 quad_perm:[1,0,3,2] row_mask:0xf bank_mask:0xf
  v_add_f32_dpp v33, v33, v33 quad_perm:[1,0,3,2] row_mask:0xf bank_mask:0xf
  v_add_f32_dpp v34, v34, v34 quad_perm:[1,0,3,2] row_mask:0xf bank_mask:0xf
  v_add_f32_dpp v35, v35, v35 quad_perm:[1,0,3,2] row_mask:0xf bank_mask:0xf
  v_add_f32_dpp v32, v32, v32 quad_perm:[2,3,0,1] row_mask:0xf bank_mask:0xf
  v_add_f32_dpp v33, v33, v33 quad_perm:[2,3,0,1] row_mask:0xf bank_mask:0xf
  v_add_f32_dpp v34, v34, v34 quad_perm:[2,3,0,1] row_mask:0xf bank_mask:0xf
  v_add_f32_dpp v35, v35, v35 quad_perm:[2,3,0,1] row_mask:0xf bank_mask:0xf
  v_add_f32_dpp v32, v32, v32 row_half_mirror row_mask:0xf bank_mask:0xf
  v_add_f32_dpp v33, v33, v33 row_half_mirror row_mask:0xf bank_mask:0xf
  v_add_f32_dpp v34, v34, v34 row_half_mirror row_mask:0xf bank_mask:0xf
  v_add_f32_dpp v35, v35, v35 row_half_mirror row_mask:0xf bank_mask:0xf
  v_add_f32_dpp v32, v32, v32 row_mirror row_mask:0xf bank_mask:0xf
  v_add_f32_dpp v33, v33, v33 row_mirror row_mask:0xf bank_mask:0xf
  v_add_f32_dpp v34, v34, v34 row_mirror row_mask:0xf bank_mask:0xf
  v_add_f32_dpp v35, v35, v35 row_mirror row_mask:0xf bank_mask:0xf
  v_mov_b32 v36, v32
  v_mov_b32 v37, v33
  v_mov_b32 v38, v34
  v_mov_b32 v39, v35
  v_permlane16_swap_b32 v32, v36
  v_permlane16_swap_b32 v33, v37
  v_permlane16_swap_b32 v34, v38
  v_permlane16_swap_b32 v35, v39
  v_add_f32 v32, v32, v36
  v_add_f32 v33, v33, v37
  v_add_f32 v34, v34, v38
  v_add_f32 v35, v35, v39
  v_mov_b32 v36, v32
  v_mov_b32 v37, v33
  v_mov_b32 v38, v34
  v_mov_b32 v39, v35
  v_permlane32_swap_b32 v32, v36
  v_permlane32_swap_b32 v33, v37
  v_permlane32_swap_b32 v34, v38
  v_permlane32_swap_b32 v35, v39
  v_add_f32 v32, v32, v36
  v_add_f32 v33, v33, v37
  v_add_f32 v34, v34, v38
  v_add_f32_e64 v35, v35, v39
  s_lshl_b32 s8, s3, 4
  s_add_u32 s8, s8, 148480
  v_mov_b32_e64 v36, s8
  ds_write_b128 v36, v[32:35]
  s_waitcnt vmcnt(0)
  ds_write_b128 v9, v[200:203]
  ds_write_b128 v9, v[204:207] offset:4608
  s_cmp_lt_u32 s2, 16
  s_cbranch_scc0 L_CI2
  s_cmp_eq_u32 s3, 0
  s_cbranch_scc0 L_CI2
  s_mov_b64 exec, 1
  v_mov_b32_e64 v37, 0
  global_atomic_add v37, v237, s[38:39] sc1
  s_mov_b64 exec, -1
L_CI2:
  v_lshrrev_b32 v9, 2, v243
  v_lshl_add_u32 v9, v242, 3, v9
  v_mul_u32_u24 v9, 144, v9
  v_and_b32_e64 v2, 3, v243
  v_lshl_add_u32 v9, v2, 3, v9
  s_lshl_b32 s8, s3, 5
  s_add_u32 s8, s8, 82432
  v_add_u32 v9, s8, v9
  s_lshl_b32 s8, s3, 4
  v_add_u32 v2, s8, v243
  v_mul_u32_u24 v2, 144, v2
  v_lshl_add_u32 v2, v242, 4, v2
  v_add_u32 v2, 91648, v2
  s_waitcnt lgkmcnt(0)
  s_barrier
  ds_read_b64_tr_b16 v[10:11], v9
  ds_read_b64_tr_b16 v[12:13], v9 offset:576
  ds_read_b64_tr_b16 v[14:15], v9 offset:4608
  ds_read_b64_tr_b16 v[16:17], v9 offset:5184
  s_cmp_lt_u32 s2, 192
  s_cbranch_scc0 WF_4
  s_nop 0
  v_add_u32 v8, 46080, v9
  ds_read_b64_tr_b16 v[200:201], v8
  ds_read_b64_tr_b16 v[202:203], v8 offset:576
  ds_read_b64_tr_b16 v[204:205], v8 offset:4608
  ds_read_b64_tr_b16 v[206:207], v8 offset:5184
  s_lshr_b32 s8, s11, 3
  s_lshl_b32 s8, s8, 19
  s_and_b32 s9, s11, 7
  s_lshl_b32 s9, s9, 2
  s_add_u32 s9, s9, s3
  s_lshl_b32 s9, s9, 14
  s_add_u32 s8, s8, s9
  s_lshl_b32 s9, s10, 11
  s_add_u32 s8, s8, s9
  s_add_u32 s8, s8, 13631488
  s_branch WF_5
WF_4:
  v_lshrrev_b32 v8, 2, v243
  v_lshrrev_b32 v7, 1, v242
  v_lshl_add_u32 v8, v7, 2, v8
  s_lshl_b32 s8, s3, 4
  v_add_u32 v8, s8, v8
  v_mul_u32_u24 v8, 144, v8
  v_and_b32_e64 v7, 1, v242
  v_lshl_add_u32 v8, v7, 5, v8
  v_and_b32_e64 v7, 3, v243
  v_lshl_add_u32 v8, v7, 3, v8
  v_add_u32 v8, 128512, v8
  ds_read_b64_tr_b16 v[200:201], v8
  ds_read_b64_tr_b16 v[202:203], v8 offset:1152
  ds_read_b64_tr_b16 v[204:205], v8 offset:64
  ds_read_b64_tr_b16 v[206:207], v8 offset:1216
  s_lshl_b32 s8, s11, 16
  s_lshl_b32 s9, s10, 2
  s_add_u32 s9, s9, s3
  s_lshl_b32 s9, s9, 11
  s_add_u32 s8, s8, s9
  s_add_u32 s8, s8, 15204352
WF_5:
  v_lshlrev_b32 v7, 4, v255
  v_add_u32_e64 v7, s8, v7
  v_mul_u32_u24 v9, 144, v1
  v_lshl_add_u32 v9, v3, 4, v9
  v_add_u32 v9, 91648, v9
  s_lshl_b32 s8, s5, 18
  s_lshl_b32 s9, s4, 7
  s_add_u32 s8, s8, s9
  s_add_u32 s8, s8, 1048576
  v_lshlrev_b32 v4, 12, v1
  v_lshl_add_u32 v4, v3, 4, v4
  v_add_u32_e64 v4, s8, v4
  v_add_u32 v5, 0x20000, v4
  s_waitcnt lgkmcnt(0)
  s_nop 0
  ds_write_b128 v2, v[10:13]
  ds_write_b128 v2, v[14:17] offset:64
  buffer_store_dwordx4 v[200:203], v7, s[44:47], 0 offen sc1
  buffer_store_dwordx4 v[204:207], v7, s[44:47], 0 offen offset:1024 sc1
  v_mov_b32_e64 v6, 0
  s_waitcnt lgkmcnt(0)
  s_barrier
  ds_read_b128 v[10:13], v9
  ds_read_b128 v[14:17], v9 offset:4608
  s_waitcnt lgkmcnt(0)
  buffer_store_dwordx4 v[10:13], v4, s[44:47], 0 offen sc1
  buffer_store_dwordx4 v[14:17], v5, s[44:47], 0 offen sc1
  global_load_dword v236, v6, s[38:39] sc1
  s_cmp_eq_u32 s3, 1
  s_cbranch_scc0 Z1_6
  s_mov_b32 exec_lo, -1
  s_mov_b32 exec_hi, 0xf
  v_mov_b32 v10, 0
  v_mov_b32 v11, 0
  v_mov_b32 v12, 0
  v_mov_b32_e64 v13, 0
  s_mul_i32 s8, s2, 576
  s_add_u32 s8, s8, 196608
  v_lshlrev_b32 v4, 4, v255
  v_add_u32 v4, s8, v4
  buffer_store_dwordx4 v[10:13], v4, s[44:47], 0 offen sc1
  s_mov_b64 exec, -1
Z1_6:
  s_cmp_eq_u32 s3, 2
  s_cbranch_scc0 Z2_7
  s_mov_b64 exec, 0xf
  v_lshlrev_b32_e64 v4, 4, v255
  v_add_u32 v5, 148480, v4
  ds_read_b128 v[10:13], v5
  s_lshl_b32 s8, s2, 6
  s_add_u32 s8, s8, 114688
  v_add_u32_e64 v4, s8, v4
  s_waitcnt lgkmcnt(0)
  buffer_store_dwordx4 v[10:13], v4, s[44:47], 0 offen sc1
  s_mov_b64 exec, -1
Z2_7:
  v_and_b32 v246, 0xffff0000, v244
  v_lshlrev_b32 v244, 16, v244
  v_lshlrev_b32 v26, 16, v26
  v_lshlrev_b32 v30, 16, v30
  v_lshlrev_b32 v27, 16, v27
  v_lshlrev_b32 v28, 16, v28
  v_mul_f32 v30, 0x3fb8aa3b, v30
  v_mul_f32 v26, 0x3fb8aa3b, v26
  v_lshlrev_b32 v29, 16, v29
  v_exp_f32 v30, v30
  v_exp_f32 v26, v26
  s_nop 0
  v_cvt_pk_bf16_f32 v31, v30, v26
  v_lshlrev_b32_e64 v30, 16, v31
  v_and_b32 v26, 0xffff0000, v31
  v_mul_f32 v40, v26, v30
  v_mul_f32 v41, v27, v30
  v_mul_f32 v42, v28, v30
  v_mul_f32 v43, v29, v30
  v_mul_f32 v40, 0xbfb8aa3b, v40
  v_mul_f32 v41, 0x3e22f983, v41
  v_add_f32 v42, v42, v42
  v_add_f32 v43, v43, v43
  v_rndne_f32 v31, v41
  v_sub_f32_e64 v41, v41, v31
  v_mul_f32 v52, 0x43800000, v40
  v_mul_f32 v58, 0x44000000, v40
  v_mul_f32 v64, 0x44c00000, v40
  v_mul_f32 v53, 0x43800000, v41
  v_mul_f32 v59, 0x44000000, v41
  v_mul_f32 v65, 0x44c00000, v41
  v_exp_f32 v52, v52
  v_exp_f32 v58, v58
  v_exp_f32 v64, v64
  v_fract_f32 v53, v53
  v_fract_f32 v59, v59
  v_fract_f32 v65, v65
  v_cos_f32 v54, v53
  v_cos_f32 v60, v59
  v_cos_f32 v66, v65
  v_sin_f32 v53, v53
  v_sin_f32 v59, v59
  v_sin_f32 v65, v65
  v_mul_f32 v55, v52, v54
  v_mul_f32 v61, v58, v60
  v_mul_f32 v67, v64, v66
  v_mul_f32 v56, v52, v53
  v_mul_f32 v62, v58, v59
  v_mul_f32 v68, v64, v65
  v_mul_f32 v44, v42, v55
  v_mul_f32 v46, v42, v61
  v_mul_f32 v48, v42, v67
  v_mul_f32 v45, v42, v56
  v_mul_f32 v47, v42, v62
  v_mul_f32 v49, v42, v68
  v_fma_f32 v44, -v43, v56, v44
  v_fma_f32 v46, -v43, v62, v46
  v_fma_f32 v48, -v43, v68, v48
  v_fma_f32 v45, v43, v55, v45
  v_fma_f32 v47, v43, v61, v47
  v_fma_f32 v49, v43, v67, v49
  v_lshrrev_b32_e64 v1, 7, v0
  v_mul_u32_u24 v1, 5120, v1
  v_and_b32 v2, 127, v0
  v_lshl_add_u32 v1, v2, 2, v1
  v_add_u32 v1, 100864, v1
  ds_write_b32 v1, v40 offset:0
  ds_write_b32 v1, v41 offset:512
  ds_write_b32 v1, v42 offset:1024
  ds_write_b32 v1, v43 offset:1536
  ds_write_b32 v1, v44 offset:2048
  ds_write_b32 v1, v45 offset:2560
  ds_write_b32 v1, v46 offset:3072
  ds_write_b32 v1, v47 offset:3584
  ds_write_b32 v1, v48 offset:4096
  ds_write_b32 v1, v49 offset:4608
  s_waitcnt lgkmcnt(0)
  s_barrier
  s_lshr_b32 s8, s3, 1
  s_mul_i32 s8, s8, 5120
  s_and_b32 s9, s3, 1
  s_lshl_b32 s9, s9, 8
  s_add_u32 s8, s8, s9
  s_add_u32 s8, s8, 100864
  v_lshlrev_b32 v1, 4, v242
  v_add_u32 v1, s8, v1
  v_cvt_f32_u32 v2, v243
  v_mov_b32 v3, v2
  v_mov_b32 v160, 0
  v_mov_b32 v161, 0
  v_mov_b32 v162, 0
  v_mov_b32 v163, 0
  v_mov_b32 v164, 0
  v_mov_b32 v165, 0
  v_mov_b32 v166, 0
  v_mov_b32 v167, 0
  v_mov_b32 v168, 0
  v_mov_b32 v169, 0
  v_mov_b32 v170, 0
  v_mov_b32 v171, 0
  v_mov_b32 v172, 0
  v_mov_b32 v173, 0
  v_mov_b32 v174, 0
  v_mov_b32_e64 v175, 0
  s_mov_b32 s12, 0
KG_8:
  ds_read_b128 v[8:11], v1 offset:0
  ds_read_b128 v[12:15], v1 offset:512
  ds_read_b128 v[84:87], v1 offset:64
  ds_read_b128 v[88:91], v1 offset:576
  ds_read_b128 v[16:19], v1 offset:1024
  ds_read_b128 v[20:23], v1 offset:1536
  ds_read_b128 v[24:27], v1 offset:2048
  ds_read_b128 v[28:31], v1 offset:2560
  ds_read_b128 v[32:35], v1 offset:3072
  ds_read_b128 v[36:39], v1 offset:3584
  ds_read_b128 v[40:43], v1 offset:4096
  ds_read_b128 v[44:47], v1 offset:4608
  ds_read_b128 v[92:95], v1 offset:1088
  ds_read_b128 v[96:99], v1 offset:1600
  ds_read_b128 v[100:103], v1 offset:2112
  ds_read_b128 v[104:107], v1 offset:2624
  ds_read_b128 v[108:111], v1 offset:3136
  ds_read_b128 v[112:115], v1 offset:3648
  ds_read_b128 v[116:119], v1 offset:4160
  ds_read_b128 v[120:123], v1 offset:4672
  s_waitcnt lgkmcnt(15)
  s_nop 0
  v_pk_mul_f32 v[56:57], v[8:9], v[2:3]
  v_pk_mul_f32 v[132:133], v[84:85], v[2:3]
  v_pk_mul_f32 v[60:61], v[12:13], v[2:3]
  v_pk_mul_f32 v[136:137], v[88:89], v[2:3]
  v_pk_mul_f32 v[58:59], v[10:11], v[2:3]
  v_pk_mul_f32 v[134:135], v[86:87], v[2:3]
  v_pk_mul_f32 v[62:63], v[14:15], v[2:3]
  v_pk_mul_f32 v[138:139], v[90:91], v[2:3]
  v_exp_f32 v56, v56
  v_exp_f32 v132, v132
  v_exp_f32 v57, v57
  v_exp_f32 v133, v133
  v_exp_f32 v58, v58
  v_exp_f32 v134, v134
  v_exp_f32 v59, v59
  v_exp_f32 v135, v135
  v_cos_f32 v48, v60
  v_cos_f32 v124, v136
  v_sin_f32 v52, v60
  v_sin_f32 v128, v136
  v_cos_f32 v49, v61
  v_cos_f32 v125, v137
  v_sin_f32 v53, v61
  v_sin_f32 v129, v137
  v_cos_f32 v50, v62
  v_cos_f32 v126, v138
  v_sin_f32 v54, v62
  v_sin_f32 v130, v138
  v_cos_f32 v51, v63
  v_cos_f32 v127, v139
  v_sin_f32 v55, v63
  v_sin_f32 v131, v139
  v_pk_mul_f32 v[48:49], v[48:49], v[56:57]
  v_pk_mul_f32 v[124:125], v[124:125], v[132:133]
  v_pk_mul_f32 v[52:53], v[52:53], v[56:57]
  v_pk_mul_f32 v[128:129], v[128:129], v[132:133]
  v_pk_mul_f32 v[50:51], v[50:51], v[58:59]
  v_pk_mul_f32 v[126:127], v[126:127], v[134:135]
  v_pk_mul_f32 v[54:55], v[54:55], v[58:59]
  v_pk_mul_f32 v[130:131], v[130:131], v[134:135]
  v_cvt_pk_bf16_f32 v72, v48, v49
  v_cvt_pk_bf16_f32 v148, v124, v125
  v_cvt_pk_bf16_f32 v73, v50, v51
  v_cvt_pk_bf16_f32 v149, v126, v127
  v_cvt_pk_bf16_f32 v74, v52, v53
  v_cvt_pk_bf16_f32 v150, v128, v129
  v_cvt_pk_bf16_f32 v75, v54, v55
  v_cvt_pk_bf16_f32 v151, v130, v131
  v_pk_mul_f32 v[56:57], v[52:53], v[52:53]
  v_pk_mul_f32 v[132:133], v[128:129], v[128:129]
  v_pk_mul_f32 v[60:61], v[48:49], v[52:53]
  v_pk_mul_f32 v[136:137], v[124:125], v[128:129]
  v_pk_mul_f32 v[58:59], v[54:55], v[54:55]
  v_pk_mul_f32 v[134:135], v[130:131], v[130:131]
  v_pk_mul_f32 v[62:63], v[50:51], v[54:55]
  v_pk_mul_f32 v[138:139], v[126:127], v[130:131]
  v_pk_fma_f32 v[48:49], v[48:49], v[48:49], v[56:57] neg_lo:[0,0,1] neg_hi:[0,0,1]
  v_pk_fma_f32 v[124:125], v[124:125], v[124:125], v[132:133] neg_lo:[0,0,1] neg_hi:[0,0,1]
  v_pk_add_f32 v[52:53], v[60:61], v[60:61]
  v_pk_add_f32 v[128:129], v[136:137], v[136:137]
  v_pk_fma_f32 v[50:51], v[50:51], v[50:51], v[58:59] neg_lo:[0,0,1] neg_hi:[0,0,1]
  v_pk_fma_f32 v[126:127], v[126:127], v[126:127], v[134:135] neg_lo:[0,0,1] neg_hi:[0,0,1]
  v_pk_add_f32 v[54:55], v[62:63], v[62:63]
  v_pk_add_f32 v[130:131], v[138:139], v[138:139]
  v_pk_mul_f32 v[56:57], v[52:53], v[52:53]
  v_pk_mul_f32 v[132:133], v[128:129], v[128:129]
  v_pk_mul_f32 v[60:61], v[48:49], v[52:53]
  v_pk_mul_f32 v[136:137], v[124:125], v[128:129]
  v_pk_mul_f32 v[58:59], v[54:55], v[54:55]
  v_pk_mul_f32 v[134:135], v[130:131], v[130:131]
  v_pk_mul_f32 v[62:63], v[50:51], v[54:55]
  v_pk_mul_f32 v[138:139], v[126:127], v[130:131]
  v_pk_fma_f32 v[48:49], v[48:49], v[48:49], v[56:57] neg_lo:[0,0,1] neg_hi:[0,0,1]
  v_pk_fma_f32 v[124:125], v[124:125], v[124:125], v[132:133] neg_lo:[0,0,1] neg_hi:[0,0,1]
  v_pk_add_f32 v[52:53], v[60:61], v[60:61]
  v_pk_add_f32 v[128:129], v[136:137], v[136:137]
  v_pk_fma_f32 v[50:51], v[50:51], v[50:51], v[58:59] neg_lo:[0,0,1] neg_hi:[0,0,1]
  v_pk_fma_f32 v[126:127], v[126:127], v[126:127], v[134:135] neg_lo:[0,0,1] neg_hi:[0,0,1]
  v_pk_add_f32 v[54:55], v[62:63], v[62:63]
  v_pk_add_f32 v[130:131], v[138:139], v[138:139]
  v_cvt_pk_bf16_f32 v76, v48, v49
  v_cvt_pk_bf16_f32 v152, v124, v125
  v_cvt_pk_bf16_f32 v77, v50, v51
  v_cvt_pk_bf16_f32 v153, v126, v127
  v_cvt_pk_bf16_f32 v78, v52, v53
  v_cvt_pk_bf16_f32 v154, v128, v129
  v_cvt_pk_bf16_f32 v79, v54, v55
  v_cvt_pk_bf16_f32 v155, v130, v131
  v_pk_mul_f32 v[56:57], v[52:53], v[52:53]
  v_pk_mul_f32 v[132:133], v[128:129], v[128:129]
  v_pk_mul_f32 v[60:61], v[48:49], v[52:53]
  v_pk_mul_f32 v[136:137], v[124:125], v[128:129]
  v_pk_mul_f32 v[58:59], v[54:55], v[54:55]
  v_pk_mul_f32 v[134:135], v[130:131], v[130:131]
  v_pk_mul_f32 v[62:63], v[50:51], v[54:55]
  v_pk_mul_f32 v[138:139], v[126:127], v[130:131]
  v_pk_fma_f32 v[48:49], v[48:49], v[48:49], v[56:57] neg_lo:[0,0,1] neg_hi:[0,0,1]
  v_pk_fma_f32 v[124:125], v[124:125], v[124:125], v[132:133] neg_lo:[0,0,1] neg_hi:[0,0,1]
  v_pk_add_f32 v[52:53], v[60:61], v[60:61]
  v_pk_add_f32 v[128:129], v[136:137], v[136:137]
  v_pk_fma_f32 v[50:51], v[50:51], v[50:51], v[58:59] neg_lo:[0,0,1] neg_hi:[0,0,1]
  v_pk_fma_f32 v[126:127], v[126:127], v[126:127], v[134:135] neg_lo:[0,0,1] neg_hi:[0,0,1]
  v_pk_add_f32 v[54:55], v[62:63], v[62:63]
  v_pk_add_f32 v[130:131], v[138:139], v[138:139]
  v_pk_mul_f32 v[56:57], v[52:53], v[52:53]
  v_pk_mul_f32 v[132:133], v[128:129], v[128:129]
  v_pk_mul_f32 v[60:61], v[48:49], v[52:53]
  v_pk_mul_f32 v[136:137], v[124:125], v[128:129]
  v_pk_mul_f32 v[58:59], v[54:55], v[54:55]
  v_pk_mul_f32 v[134:135], v[130:131], v[130:131]
  v_pk_mul_f32 v[62:63], v[50:51], v[54:55]
  v_pk_mul_f32 v[138:139], v[126:127], v[130:131]
  v_pk_fma_f32 v[48:49], v[48:49], v[48:49], v[56:57] neg_lo:[0,0,1] neg_hi:[0,0,1]
  v_pk_fma_f32 v[124:125], v[124:125], v[124:125], v[132:133] neg_lo:[0,0,1] neg_hi:[0,0,1]
  v_pk_add_f32 v[52:53], v[60:61], v[60:61]
  v_pk_add_f32 v[128:129], v[136:137], v[136:137]
  v_pk_fma_f32 v[50:51], v[50:51], v[50:51], v[58:59] neg_lo:[0,0,1] neg_hi:[0,0,1]
  v_pk_fma_f32 v[126:127], v[126:127], v[126:127], v[134:135] neg_lo:[0,0,1] neg_hi:[0,0,1]
  v_pk_add_f32 v[54:55], v[62:63], v[62:63]
  v_pk_add_f32 v[130:131], v[138:139], v[138:139]
  s_waitcnt lgkmcnt(0)
  s_nop 0
  v_pk_mul_f32 v[56:57], v[20:21], v[52:53]
  v_pk_mul_f32 v[132:133], v[96:97], v[128:129]
  v_pk_mul_f32 v[60:61], v[20:21], v[48:49]
  v_pk_mul_f32 v[136:137], v[96:97], v[124:125]
  v_pk_mul_f32 v[58:59], v[22:23], v[54:55]
  v_pk_mul_f32 v[134:135], v[98:99], v[130:131]
  v_pk_mul_f32 v[62:63], v[22:23], v[50:51]
  v_pk_mul_f32 v[138:139], v[98:99], v[126:127]
  v_pk_fma_f32 v[56:57], v[16:17], v[48:49], v[56:57] neg_lo:[0,0,1] neg_hi:[0,0,1]
  v_pk_fma_f32 v[132:133], v[92:93], v[124:125], v[132:133] neg_lo:[0,0,1] neg_hi:[0,0,1]
  v_pk_fma_f32 v[60:61], v[16:17], v[52:53], v[60:61] neg_lo:[1,0,1] neg_hi:[1,0,1]
  v_pk_fma_f32 v[136:137], v[92:93], v[128:129], v[136:137] neg_lo:[1,0,1] neg_hi:[1,0,1]
  v_pk_fma_f32 v[58:59], v[18:19], v[50:51], v[58:59] neg_lo:[0,0,1] neg_hi:[0,0,1]
  v_pk_fma_f32 v[134:135], v[94:95], v[126:127], v[134:135] neg_lo:[0,0,1] neg_hi:[0,0,1]
  v_pk_fma_f32 v[62:63], v[18:19], v[54:55], v[62:63] neg_lo:[1,0,1] neg_hi:[1,0,1]
  v_pk_fma_f32 v[138:139], v[94:95], v[130:131], v[138:139] neg_lo:[1,0,1] neg_hi:[1,0,1]
  v_cvt_pk_bf16_f32 v64, v56, v57
  v_cvt_pk_bf16_f32 v140, v132, v133
  v_cvt_pk_bf16_f32 v65, v58, v59
  v_cvt_pk_bf16_f32 v141, v134, v135
  v_cvt_pk_bf16_f32 v66, v60, v61
  v_cvt_pk_bf16_f32 v142, v136, v137
  v_cvt_pk_bf16_f32 v67, v62, v63
  v_cvt_pk_bf16_f32 v143, v138, v139
  s_nop 0
  s_nop 0
  v_mfma_f32_16x16x32_bf16 v[160:163], v[64:67], v[72:75], v[160:163]
  v_mfma_f32_16x16x32_bf16 v[160:163], v[140:143], v[148:151], v[160:163]
  v_pk_mul_f32 v[56:57], v[28:29], v[52:53]
  v_pk_mul_f32 v[132:133], v[104:105], v[128:129]
  v_pk_mul_f32 v[60:61], v[28:29], v[48:49]
  v_pk_mul_f32 v[136:137], v[104:105], v[124:125]
  v_pk_mul_f32 v[58:59], v[30:31], v[54:55]
  v_pk_mul_f32 v[134:135], v[106:107], v[130:131]
  v_pk_mul_f32 v[62:63], v[30:31], v[50:51]
  v_pk_mul_f32 v[138:139], v[106:107], v[126:127]
  v_pk_fma_f32 v[56:57], v[24:25], v[48:49], v[56:57] neg_lo:[0,0,1] neg_hi:[0,0,1]
  v_pk_fma_f32 v[132:133], v[100:101], v[124:125], v[132:133] neg_lo:[0,0,1] neg_hi:[0,0,1]
  v_pk_fma_f32 v[60:61], v[24:25], v[52:53], v[60:61] neg_lo:[1,0,1] neg_hi:[1,0,1]
  v_pk_fma_f32 v[136:137], v[100:101], v[128:129], v[136:137] neg_lo:[1,0,1] neg_hi:[1,0,1]
  v_pk_fma_f32 v[58:59], v[26:27], v[50:51], v[58:59] neg_lo:[0,0,1] neg_hi:[0,0,1]
  v_pk_fma_f32 v[134:135], v[102:103], v[126:127], v[134:135] neg_lo:[0,0,1] neg_hi:[0,0,1]
  v_pk_fma_f32 v[62:63], v[26:27], v[54:55], v[62:63] neg_lo:[1,0,1] neg_hi:[1,0,1]
  v_pk_fma_f32 v[138:139], v[102:103], v[130:131], v[138:139] neg_lo:[1,0,1] neg_hi:[1,0,1]
  v_cvt_pk_bf16_f32 v68, v56, v57
  v_cvt_pk_bf16_f32 v144, v132, v133
  v_cvt_pk_bf16_f32 v69, v58, v59
  v_cvt_pk_bf16_f32 v145, v134, v135
  v_cvt_pk_bf16_f32 v70, v60, v61
  v_cvt_pk_bf16_f32 v146, v136, v137
  v_cvt_pk_bf16_f32 v71, v62, v63
  v_cvt_pk_bf16_f32 v147, v138, v139
  s_nop 0
  s_nop 0
  v_mfma_f32_16x16x32_bf16 v[164:167], v[68:71], v[72:75], v[164:167]
  v_mfma_f32_16x16x32_bf16 v[164:167], v[144:147], v[148:151], v[164:167]
  v_pk_mul_f32 v[56:57], v[52:53], v[52:53]
  v_pk_mul_f32 v[132:133], v[128:129], v[128:129]
  v_pk_mul_f32 v[60:61], v[48:49], v[52:53]
  v_pk_mul_f32 v[136:137], v[124:125], v[128:129]
  v_pk_mul_f32 v[58:59], v[54:55], v[54:55]
  v_pk_mul_f32 v[134:135], v[130:131], v[130:131]
  v_pk_mul_f32 v[62:63], v[50:51], v[54:55]
  v_pk_mul_f32 v[138:139], v[126:127], v[130:131]
  v_pk_fma_f32 v[48:49], v[48:49], v[48:49], v[56:57] neg_lo:[0,0,1] neg_hi:[0,0,1]
  v_pk_fma_f32 v[124:125], v[124:125], v[124:125], v[132:133] neg_lo:[0,0,1] neg_hi:[0,0,1]
  v_pk_add_f32 v[52:53], v[60:61], v[60:61]
  v_pk_add_f32 v[128:129], v[136:137], v[136:137]
  v_pk_fma_f32 v[50:51], v[50:51], v[50:51], v[58:59] neg_lo:[0,0,1] neg_hi:[0,0,1]
  v_pk_fma_f32 v[126:127], v[126:127], v[126:127], v[134:135] neg_lo:[0,0,1] neg_hi:[0,0,1]
  v_pk_add_f32 v[54:55], v[62:63], v[62:63]
  v_pk_add_f32 v[130:131], v[138:139], v[138:139]
  v_pk_mul_f32 v[56:57], v[52:53], v[52:53]
  v_pk_mul_f32 v[132:133], v[128:129], v[128:129]
  v_pk_mul_f32 v[60:61], v[48:49], v[52:53]
  v_pk_mul_f32 v[136:137], v[124:125], v[128:129]
  v_pk_mul_f32 v[58:59], v[54:55], v[54:55]
  v_pk_mul_f32 v[134:135], v[130:131], v[130:131]
  v_pk_mul_f32 v[62:63], v[50:51], v[54:55]
  v_pk_mul_f32 v[138:139], v[126:127], v[130:131]
  v_pk_fma_f32 v[48:49], v[48:49], v[48:49], v[56:57] neg_lo:[0,0,1] neg_hi:[0,0,1]
  v_pk_fma_f32 v[124:125], v[124:125], v[124:125], v[132:133] neg_lo:[0,0,1] neg_hi:[0,0,1]
  v_pk_add_f32 v[52:53], v[60:61], v[60:61]
  v_pk_add_f32 v[128:129], v[136:137], v[136:137]
  v_pk_fma_f32 v[50:51], v[50:51], v[50:51], v[58:59] neg_lo:[0,0,1] neg_hi:[0,0,1]
  v_pk_fma_f32 v[126:127], v[126:127], v[126:127], v[134:135] neg_lo:[0,0,1] neg_hi:[0,0,1]
  v_pk_add_f32 v[54:55], v[62:63], v[62:63]
  v_pk_add_f32 v[130:131], v[138:139], v[138:139]
  v_pk_mul_f32 v[56:57], v[36:37], v[52:53]
  v_pk_mul_f32 v[132:133], v[112:113], v[128:129]
  v_pk_mul_f32 v[60:61], v[36:37], v[48:49]
  v_pk_mul_f32 v[136:137], v[112:113], v[124:125]
  v_pk_mul_f32 v[58:59], v[38:39], v[54:55]
  v_pk_mul_f32 v[134:135], v[114:115], v[130:131]
  v_pk_mul_f32 v[62:63], v[38:39], v[50:51]
  v_pk_mul_f32 v[138:139], v[114:115], v[126:127]
  v_pk_fma_f32 v[56:57], v[32:33], v[48:49], v[56:57] neg_lo:[0,0,1] neg_hi:[0,0,1]
  v_pk_fma_f32 v[132:133], v[108:109], v[124:125], v[132:133] neg_lo:[0,0,1] neg_hi:[0,0,1]
  v_pk_fma_f32 v[60:61], v[32:33], v[52:53], v[60:61] neg_lo:[1,0,1] neg_hi:[1,0,1]
  v_pk_fma_f32 v[136:137], v[108:109], v[128:129], v[136:137] neg_lo:[1,0,1] neg_hi:[1,0,1]
  v_pk_fma_f32 v[58:59], v[34:35], v[50:51], v[58:59] neg_lo:[0,0,1] neg_hi:[0,0,1]
  v_pk_fma_f32 v[134:135], v[110:111], v[126:127], v[134:135] neg_lo:[0,0,1] neg_hi:[0,0,1]
  v_pk_fma_f32 v[62:63], v[34:35], v[54:55], v[62:63] neg_lo:[1,0,1] neg_hi:[1,0,1]
  v_pk_fma_f32 v[138:139], v[110:111], v[130:131], v[138:139] neg_lo:[1,0,1] neg_hi:[1,0,1]
  v_cvt_pk_bf16_f32 v64, v56, v57
  v_cvt_pk_bf16_f32 v140, v132, v133
  v_cvt_pk_bf16_f32 v65, v58, v59
  v_cvt_pk_bf16_f32 v141, v134, v135
  v_cvt_pk_bf16_f32 v66, v60, v61
  v_cvt_pk_bf16_f32 v142, v136, v137
  v_cvt_pk_bf16_f32 v67, v62, v63
  v_cvt_pk_bf16_f32 v143, v138, v139
  s_nop 0
  s_nop 0
  v_mfma_f32_16x16x32_bf16 v[168:171], v[64:67], v[76:79], v[168:171]
  v_mfma_f32_16x16x32_bf16 v[168:171], v[140:143], v[152:155], v[168:171]
  v_pk_mul_f32 v[56:57], v[44:45], v[52:53]
  v_pk_mul_f32 v[132:133], v[120:121], v[128:129]
  v_pk_mul_f32 v[60:61], v[44:45], v[48:49]
  v_pk_mul_f32 v[136:137], v[120:121], v[124:125]
  v_pk_mul_f32 v[58:59], v[46:47], v[54:55]
  v_pk_mul_f32 v[134:135], v[122:123], v[130:131]
  v_pk_mul_f32 v[62:63], v[46:47], v[50:51]
  v_pk_mul_f32 v[138:139], v[122:123], v[126:127]
  v_pk_fma_f32 v[56:57], v[40:41], v[48:49], v[56:57] neg_lo:[0,0,1] neg_hi:[0,0,1]
  v_pk_fma_f32 v[132:133], v[116:117], v[124:125], v[132:133] neg_lo:[0,0,1] neg_hi:[0,0,1]
  v_pk_fma_f32 v[60:61], v[40:41], v[52:53], v[60:61] neg_lo:[1,0,1] neg_hi:[1,0,1]
  v_pk_fma_f32 v[136:137], v[116:117], v[128:129], v[136:137] neg_lo:[1,0,1] neg_hi:[1,0,1]
  v_pk_fma_f32 v[58:59], v[42:43], v[50:51], v[58:59] neg_lo:[0,0,1] neg_hi:[0,0,1]
  v_pk_fma_f32 v[134:135], v[118:119], v[126:127], v[134:135] neg_lo:[0,0,1] neg_hi:[0,0,1]
  v_pk_fma_f32 v[62:63], v[42:43], v[54:55], v[62:63] neg_lo:[1,0,1] neg_hi:[1,0,1]
  v_pk_fma_f32 v[138:139], v[118:119], v[130:131], v[138:139] neg_lo:[1,0,1] neg_hi:[1,0,1]
  v_cvt_pk_bf16_f32 v68, v56, v57
  v_cvt_pk_bf16_f32 v144, v132, v133
  v_cvt_pk_bf16_f32 v69, v58, v59
  v_cvt_pk_bf16_f32 v145, v134, v135
  v_cvt_pk_bf16_f32 v70, v60, v61
  v_cvt_pk_bf16_f32 v146, v136, v137
  v_cvt_pk_bf16_f32 v71, v62, v63
  v_cvt_pk_bf16_f32 v147, v138, v139
  s_nop 0
  v_mfma_f32_16x16x32_bf16 v[172:175], v[68:71], v[76:79], v[172:175]
  v_mfma_f32_16x16x32_bf16 v[172:175], v[144:147], v[152:155], v[172:175]
  v_add_u32 v1, 128, v1
  s_cmp_eq_u32 s12, 0
  s_cbranch_scc0 KG_9
  s_waitcnt vmcnt(0)
  s_barrier
  s_add_u32 s7, s7, 16
  s_cmp_eq_u32 s3, 0
  s_cbranch_scc0 ARR1_10
  s_mov_b64 exec, 1
  s_mov_b32 s78, 0
  v_mov_b32 v6, 0
INITP_11:
  v_cmp_le_u32 vcc, 16, v236
  s_nop 4
  s_cbranch_vccnz INITD_12
  global_load_dword v236, v6, s[38:39] sc1
  s_add_u32 s78, s78, 1
  s_waitcnt vmcnt(0)
  s_cmp_lt_u32 s78, 0x200000
  s_cbranch_scc1 INITP_11
INITD_12:
  v_mov_b32 v232, 1
  buffer_atomic_add v232, v239, s[44:47], 0 offen sc0 sc1
  s_mov_b64 exec, -1
ARR1_10:
  s_mov_b32 s12, 1
  s_branch KG_8
KG_9:
  s_nop 7
  s_cmp_eq_u32 s3, 0
  s_cbranch_scc0 AF_13
  s_mov_b64 exec, 1
  s_mov_b64 exec, -1
AF_13:
  s_lshr_b32 s8, s3, 1
  s_mul_i32 s8, s8, 4224
  s_and_b32 s9, s3, 1
  s_mul_i32 s9, s9, 8448
  s_add_u32 s8, s8, s9
  s_add_u32 s8, s8, 111104
  v_mul_u32_u24 v1, 264, v242
  v_lshl_add_u32 v1, v243, 2, v1
  v_add_u32 v1, s8, v1
  ds_write_b32 v1, v160 offset:0
  ds_write_b32 v1, v161 offset:64
  ds_write_b32 v1, v162 offset:132
  ds_write_b32 v1, v163 offset:196
  ds_write_b32 v1, v164 offset:1056
  ds_write_b32 v1, v165 offset:1120
  ds_write_b32 v1, v166 offset:1188
  ds_write_b32 v1, v167 offset:1252
  ds_write_b32 v1, v168 offset:2112
  ds_write_b32 v1, v169 offset:2176
  ds_write_b32 v1, v170 offset:2244
  ds_write_b32 v1, v171 offset:2308
  ds_write_b32 v1, v172 offset:3168
  ds_write_b32 v1, v173 offset:3232
  ds_write_b32 v1, v174 offset:3300
  ds_write_b32 v1, v175 offset:3364
  s_waitcnt vmcnt(0) lgkmcnt(0)
  s_barrier
  ds_read_b32 v8, v180 offset:0
  ds_read_b32 v9, v181 offset:0
  ds_read_b32 v10, v182 offset:0
  ds_read_b32 v11, v183 offset:0
  ds_read_b32 v12, v184 offset:0
  ds_read_b32 v13, v185 offset:0
  ds_read_b32 v14, v186 offset:0
  ds_read_b32 v15, v187 offset:0
  ds_read_b32 v16, v188 offset:0
  ds_read_b32 v17, v180 offset:4224
  ds_read_b32 v18, v181 offset:4224
  ds_read_b32 v19, v182 offset:4224
  ds_read_b32 v20, v183 offset:4224
  ds_read_b32 v21, v184 offset:4224
  ds_read_b32 v22, v185 offset:4224
  ds_read_b32 v23, v186 offset:4224
  ds_read_b32 v24, v187 offset:4224
  ds_read_b32 v25, v188 offset:4224
  ds_read_b32 v26, v180 offset:8448
  ds_read_b32 v27, v181 offset:8448
  ds_read_b32 v28, v182 offset:8448
  ds_read_b32 v29, v183 offset:8448
  ds_read_b32 v30, v184 offset:8448
  ds_read_b32 v31, v185 offset:8448
  ds_read_b32 v32, v186 offset:8448
  ds_read_b32 v33, v187 offset:8448
  ds_read_b32 v34, v188 offset:8448
  ds_read_b32 v35, v180 offset:12672
  ds_read_b32 v36, v181 offset:12672
  ds_read_b32 v37, v182 offset:12672
  ds_read_b32 v38, v183 offset:12672
  ds_read_b32 v39, v184 offset:12672
  ds_read_b32 v40, v185 offset:12672
  ds_read_b32 v41, v186 offset:12672
  ds_read_b32 v42, v187 offset:12672
  ds_read_b32 v43, v188 offset:12672
  v_cmp_ne_u32 vcc, 255, v0
  v_lshlrev_b32_e64 v1, 4, v0
  v_add_u32 v1, 65544, v1
  s_waitcnt lgkmcnt(0)
  v_add_f32 v8, v8, v26
  v_add_f32 v9, v9, v27
  v_add_f32 v10, v10, v28
  v_add_f32 v11, v11, v29
  v_add_f32 v12, v12, v30
  v_add_f32 v13, v13, v31
  v_add_f32 v14, v14, v32
  v_add_f32 v15, v15, v33
  v_add_f32 v16, v16, v34
  v_add_f32 v17, v17, v35
  v_add_f32 v18, v18, v36
  v_add_f32 v19, v19, v37
  v_add_f32 v20, v20, v38
  v_add_f32 v21, v21, v39
  v_add_f32 v22, v22, v40
  v_add_f32 v23, v23, v41
  v_add_f32 v24, v24, v42
  v_add_f32_e64 v25, v25, v43
  v_cndmask_b32 v16, 0, v16, vcc
  v_cndmask_b32 v25, 0, v25, vcc
  v_cvt_pk_bf16_f32 v80, v9, v10
  v_cvt_pk_bf16_f32 v81, v11, v12
  v_cvt_pk_bf16_f32 v82, v13, v14
  v_cvt_pk_bf16_f32 v83, v15, v16
  ds_write_b64 v1, v[80:81] offset:0
  ds_write_b64 v1, v[82:83] offset:8
  v_cvt_pk_bf16_f32 v84, v8, v9
  v_cvt_pk_bf16_f32 v85, v10, v11
  v_cvt_pk_bf16_f32 v86, v12, v13
  v_cvt_pk_bf16_f32 v87, v14, v15
  ds_write_b64 v1, v[84:85] offset:4224
  ds_write_b64 v1, v[86:87] offset:4232
  v_cvt_pk_bf16_f32 v88, v18, v19
  v_cvt_pk_bf16_f32 v89, v20, v21
  v_cvt_pk_bf16_f32 v90, v22, v23
  v_cvt_pk_bf16_f32 v91, v24, v25
  ds_write_b64 v1, v[88:89] offset:8448
  ds_write_b64 v1, v[90:91] offset:8456
  v_cvt_pk_bf16_f32 v92, v17, v18
  v_cvt_pk_bf16_f32 v93, v19, v20
  v_cvt_pk_bf16_f32 v94, v21, v22
  v_cvt_pk_bf16_f32 v95, v23, v24
  ds_write_b64 v1, v[92:93] offset:12672
  ds_write_b64 v1, v[94:95] offset:12680
  v_cmp_gt_u32 vcc, 14, v243
  v_mul_u32_u24 v1, 4224, v242
  v_lshl_add_u32 v1, v243, 2, v1
  v_add_u32 v1, 69640, v1
  v_mov_b32_e64 v2, 0
  s_cmp_eq_u32 s3, 0
  s_cselect_b64 s[70:71], vcc, 0
  s_mov_b64 exec, s[70:71]
  ds_write_b32 v1, v2
  s_mov_b64 exec, -1
  s_waitcnt lgkmcnt(0)
  s_barrier
L_LAYER:
  s_nop 0
  s_mul_i32 s72, s6, 0x400000
  s_add_u32 s72, s72, 0x100000
  s_mul_i32 s73, s6, 0x400000
  s_add_u32 s73, s73, 0x300000
  s_mul_i32 s74, s6, 0x34000
  s_add_u32 s74, s74, 0x1c000
  s_mul_i32 s75, s6, 0x200000
  s_add_u32 s75, s75, 0x900000
  s_mul_i32 s76, s6, 0x8000
  s_add_u32 s76, s76, 0x30000
  s_mul_i32 s77, s6, 0x8000
  s_add_u32 s77, s77, 0x40000
  s_lshl_b32 s8, s2, 13
  s_add_u32 s8, s8, s72
  v_lshlrev_b32 v3, 4, v0
  v_add_u32 v3, s8, v3
  v_lshlrev_b32 v4, 4, v0
  v_add_u32 v4, s74, v4
  v_lshlrev_b32_e64 v5, 4, v0
  v_add_u32 v5, 82944, v5
  v_add_u32 v6, 9280, v5
  v_bfe_u32 v1, v0, 5, 2
  v_mul_u32_u24 v1, 4640, v1
  v_and_b32_e64 v2, 31, v0
  v_lshl_add_u32 v1, v2, 4, v1
  v_add_u32 v1, 82432, v1
  v_mov_b32 v36, 0
  v_mov_b32 v37, 0
  v_mov_b32 v38, 0
  v_mov_b32 v39, 0
  v_and_b32_e64 v2, 1, v0
  v_mul_u32_u24 v2, 9280, v2
  v_add_u32 v2, 82944, v2
  ds_write_b32 v2, v36
  v_cmp_gt_u32 vcc, 128, v0
  s_nop 3
  s_and_saveexec_b64 s[70:71], vcc
  ds_write_b128 v1, v[36:39]
  s_mov_b64 exec, -1
  s_lshr_b32 s8, s3, 1
  s_and_b32 s9, s3, 1
  s_mul_i32 s10, s8, 8448
  s_lshl_b32 s11, s9, 8
  s_sub_u32 s10, s10, s11
  s_add_u32 s10, s10, 65856
  v_and_b32 v1, 1, v243
  v_lshrrev_b32_e64 v7, 1, v243
  v_mul_u32_u24 v8, 4224, v1
  v_lshl_add_u32 v8, v242, 4, v8
  v_lshlrev_b32 v9, 3, v7
  v_sub_u32 v8, v8, v9
  v_add_u32_e64 v8, s10, v8
  s_mul_i32 s10, s8, 9280
  s_sub_u32 s10, s10, s11
  s_nop 0
  s_add_u32 s10, s10, 82752
  v_mul_u32_u24 v9, 4640, v1
  v_lshl_add_u32 v9, v7, 6, v9
  v_lshl_add_u32 v9, v242, 4, v9
  v_add_u32_e64 v9, s10, v9
  s_lshl_b32 s9, s9, 1
  s_add_u32 s8, s8, s9
  s_mul_i32 s8, s8, 9216
  s_add_u32 s8, s8, 100992
  v_mul_u32_u24 v2, 144, v7
  v_lshl_add_u32 v2, v242, 5, v2
  v_lshl_add_u32 v2, v1, 3, v2
  v_add_u32 v2, s8, v2
  v_lshrrev_b32 v7, 2, v0
  v_lshlrev_b32_e64 v7, 4, v7
  v_lshl_add_u32 v7, v0, 5, v7
  v_add_u32 v7, 100992, v7
  s_waitcnt lgkmcnt(0)
  s_nop 0
  ds_read_b64 v[112:113], v8 offset:3776
  ds_read_b64 v[114:115], v8 offset:3784
  ds_read_b64 v[116:117], v8 offset:3264
  ds_read_b64 v[118:119], v8 offset:3272
  ds_read_b64 v[120:121], v8 offset:2752
  ds_read_b64 v[122:123], v8 offset:2760
  ds_read_b64 v[124:125], v8 offset:2240
  ds_read_b64 v[126:127], v8 offset:2248
  ds_read_b64 v[128:129], v8 offset:1728
  ds_read_b64 v[130:131], v8 offset:1736
  ds_read_b64 v[132:133], v8 offset:1216
  ds_read_b64 v[134:135], v8 offset:1224
  ds_read_b64 v[136:137], v8 offset:704
  ds_read_b64 v[138:139], v8 offset:712
  ds_read_b64 v[140:141], v8 offset:192
  ds_read_b64 v[142:143], v8 offset:200
  ds_read_b64 a[192:193], v8 offset:3712
  ds_read_b64 a[194:195], v8 offset:3720
  ds_read_b64 a[196:197], v8 offset:3200
  ds_read_b64 a[198:199], v8 offset:3208
  ds_read_b64 a[200:201], v8 offset:2688
  ds_read_b64 a[202:203], v8 offset:2696
  ds_read_b64 a[204:205], v8 offset:2176
  ds_read_b64 a[206:207], v8 offset:2184
  ds_read_b64 a[208:209], v8 offset:1664
  ds_read_b64 a[210:211], v8 offset:1672
  ds_read_b64 a[212:213], v8 offset:1152
  ds_read_b64 a[214:215], v8 offset:1160
  ds_read_b64 a[216:217], v8 offset:640
  ds_read_b64 a[218:219], v8 offset:648
  ds_read_b64 a[220:221], v8 offset:128
  ds_read_b64 a[222:223], v8 offset:136
  ds_read_b64 a[224:225], v8 offset:3584
  ds_read_b64 a[226:227], v8 offset:3592
  ds_read_b64 a[228:229], v8 offset:3072
  ds_read_b64 a[230:231], v8 offset:3080
  ds_read_b64 a[232:233], v8 offset:2560
  ds_read_b64 a[234:235], v8 offset:2568
  ds_read_b64 a[236:237], v8 offset:2048
  ds_read_b64 a[238:239], v8 offset:2056
  ds_read_b64 a[240:241], v8 offset:1536
  ds_read_b64 a[242:243], v8 offset:1544
  ds_read_b64 a[244:245], v8 offset:1024
  ds_read_b64 a[246:247], v8 offset:1032
  ds_read_b64 a[248:249], v8 offset:512
  ds_read_b64 a[250:251], v8 offset:520
  ds_read_b64 a[252:253], v8 offset:0
  ds_read_b64 a[254:255], v8 offset:8
  s_cmp_eq_u32 s3, 0
  s_cbranch_scc0 WT_14
  s_mov_b64 exec, 0xffff
  s_mov_b32 s78, 0
  s_cmp_eq_u32 s6, 0
  s_cselect_b32 s9, 0, 1
  s_waitcnt vmcnt(0)
  v_readfirstlane_b32 s8, v232
  s_nop 3
  s_and_b32 s8, s8, 15
  s_sub_u32 s8, 15, s8
  s_mul_i32 s8, s8, s9
  s_add_u32 s8, s8, 0
AD_18:
  s_sleep 1
  s_sub_u32 s8, s8, 1
  s_cmp_gt_i32 s8, 0
  s_cbranch_scc1 AD_18
POLL_15:
  buffer_load_dword v236, v238, s[44:47], 0 offen offset:0 sc1
  s_add_u32 s78, s78, 1
  s_waitcnt vmcnt(0)
  v_cmp_gt_u32 vcc, s7, v236
  s_nop 4
  s_cbranch_vccz PD_16
  s_sleep 4
  s_cmp_lt_u32 s78, 0x200000
  s_cbranch_scc1 POLL_15
PD_16:
  s_mov_b64 exec, -1
WT_14:
  s_barrier
  s_mov_b32 s8, 0
  buffer_load_dwordx4 v[20:23], v4, s[44:47], s8 offen sc1
  s_mov_b32 s8, 4096
  buffer_load_dwordx4 v[24:27], v4, s[44:47], s8 offen sc1
  s_mov_b32 s8, 8192
  buffer_load_dwordx4 v[28:31], v4, s[44:47], s8 offen sc1
  s_mov_b32 s8, 12288
  buffer_load_dwordx4 v[32:35], v4, s[44:47], s8 offen sc1
  buffer_load_dwordx4 v[10:13], v3, s[44:47], 0 offen sc1
  v_add_u32 v1, 4096, v3
  buffer_load_dwordx4 v[14:17], v1, s[44:47], 0 offen sc1
  s_mov_b32 s66, 0x3b000000
  s_mov_b32 s67, 0x3727c5ac
  v_mov_b32 v36, s66
  v_mov_b32 v37, s66
  v_mov_b32 v38, s67
  v_mov_b32 v39, s67
  s_cmp_eq_u32 s6, 0
  s_cselect_b64 vcc, -1, 0
  s_cbranch_scc0 CW_20
  s_lshl_b32 s8, s5, 2
  s_add_u32 s8, s8, s3
  s_lshl_b32 s8, s8, 14
  s_add_u32 s79, s8, 13631488
  s_add_u32 s15, s79, 524288
  v_lshlrev_b32_e64 v18, 4, v255
  buffer_load_dwordx4 a[64:67], v18, s[44:47], s15 offen sc1
  s_add_u32 s15, s15, 1024
  buffer_load_dwordx4 a[68:71], v18, s[44:47], s15 offen sc1
  s_add_u32 s15, s15, 1024
  buffer_load_dwordx4 a[72:75], v18, s[44:47], s15 offen sc1
  s_add_u32 s15, s15, 1024
  buffer_load_dwordx4 a[76:79], v18, s[44:47], s15 offen sc1
  s_add_u32 s15, s15, 1024
  buffer_load_dwordx4 a[80:83], v18, s[44:47], s15 offen sc1
  s_add_u32 s15, s15, 1024
  buffer_load_dwordx4 a[84:87], v18, s[44:47], s15 offen sc1
  s_add_u32 s15, s15, 1024
  buffer_load_dwordx4 a[88:91], v18, s[44:47], s15 offen sc1
  s_add_u32 s15, s15, 1024
  buffer_load_dwordx4 a[92:95], v18, s[44:47], s15 offen sc1
  s_add_u32 s15, s15, 1024
  s_waitcnt vmcnt(10)
  s_branch CW_21
CW_20:
  s_waitcnt vmcnt(2)
CW_21:
  s_nop 0
  v_pk_mul_f32 v[20:21], v[20:21], v[36:37]
  v_pk_mul_f32 v[22:23], v[22:23], v[36:37]
  v_pk_mul_f32 v[24:25], v[24:25], v[36:37]
  v_pk_mul_f32 v[26:27], v[26:27], v[36:37]
  v_pk_mul_f32 v[28:29], v[28:29], v[36:37]
  v_pk_mul_f32 v[30:31], v[30:31], v[36:37]
  v_pk_mul_f32 v[32:33], v[32:33], v[36:37]
  v_pk_mul_f32 v[34:35], v[34:35], v[36:37]
  v_fma_f32 v21, -v20, v20, v21
  v_fma_f32 v23, -v22, v22, v23
  v_fma_f32 v25, -v24, v24, v25
  v_fma_f32 v27, -v26, v26, v27
  v_fma_f32 v29, -v28, v28, v29
  v_fma_f32 v31, -v30, v30, v31
  v_fma_f32 v33, -v32, v32, v33
  v_fma_f32 v35, -v34, v34, v35
  v_cvt_pk_bf16_f32 v40, v20, v21
  v_cvt_pk_bf16_f32 v41, v22, v23
  v_cvt_pk_bf16_f32 v42, v24, v25
  v_cvt_pk_bf16_f32 v43, v26, v27
  v_cvt_pk_bf16_f32 v44, v28, v29
  v_cvt_pk_bf16_f32 v45, v30, v31
  v_cvt_pk_bf16_f32 v46, v32, v33
  v_cvt_pk_bf16_f32 v47, v34, v35
  v_and_b32 v56, 0xffff0000, v40
  v_and_b32 v57, 0xffff0000, v41
  v_and_b32 v58, 0xffff0000, v42
  v_and_b32 v59, 0xffff0000, v43
  v_and_b32 v60, 0xffff0000, v44
  v_and_b32 v61, 0xffff0000, v45
  v_and_b32 v62, 0xffff0000, v46
  v_and_b32 v63, 0xffff0000, v47
  v_pk_add_f32 v[56:57], v[56:57], v[38:39]
  v_pk_add_f32 v[58:59], v[58:59], v[38:39]
  v_pk_add_f32 v[60:61], v[60:61], v[38:39]
  v_pk_add_f32 v[62:63], v[62:63], v[38:39]
  v_lshlrev_b32 v48, 16, v40
  v_lshlrev_b32 v49, 16, v41
  v_lshlrev_b32 v50, 16, v42
  v_lshlrev_b32 v51, 16, v43
  v_lshlrev_b32 v52, 16, v44
  v_lshlrev_b32 v53, 16, v45
  v_lshlrev_b32 v54, 16, v46
  v_lshlrev_b32 v55, 16, v47
  v_cvt_pk_bf16_f32 v40, v56, v57
  v_cvt_pk_bf16_f32 v41, v58, v59
  v_cvt_pk_bf16_f32 v42, v60, v61
  v_cvt_pk_bf16_f32 v43, v62, v63
  v_lshlrev_b32_e64 v56, 16, v40
  v_and_b32 v57, 0xffff0000, v40
  v_lshlrev_b32_e64 v58, 16, v41
  v_and_b32 v59, 0xffff0000, v41
  v_lshlrev_b32_e64 v60, 16, v42
  v_and_b32 v61, 0xffff0000, v42
  v_lshlrev_b32_e64 v62, 16, v43
  v_and_b32 v63, 0xffff0000, v43
  v_sqrt_f32 v56, v56
  v_sqrt_f32 v57, v57
  v_sqrt_f32 v58, v58
  v_sqrt_f32 v59, v59
  v_sqrt_f32 v60, v60
  v_sqrt_f32 v61, v61
  v_sqrt_f32 v62, v62
  v_sqrt_f32 v63, v63
  v_cvt_pk_bf16_f32 v40, v56, v57
  v_cvt_pk_bf16_f32 v41, v58, v59
  v_cvt_pk_bf16_f32 v42, v60, v61
  v_cvt_pk_bf16_f32 v43, v62, v63
  v_lshlrev_b32_e64 v56, 16, v40
  v_and_b32 v57, 0xffff0000, v40
  v_lshlrev_b32_e64 v58, 16, v41
  v_and_b32 v59, 0xffff0000, v41
  v_lshlrev_b32_e64 v60, 16, v42
  v_and_b32 v61, 0xffff0000, v42
  v_lshlrev_b32_e64 v62, 16, v43
  v_and_b32 v63, 0xffff0000, v43
  s_cbranch_vccz CW_22
  s_waitcnt vmcnt(8)
  s_branch CW_23
CW_22:
  s_waitcnt vmcnt(0)
CW_23:
  v_rcp_f32 v64, v56
  v_lshlrev_b32 v200, 16, v10
  v_and_b32 v201, 0xffff0000, v10
  v_rcp_f32 v65, v57
  v_lshlrev_b32 v202, 16, v11
  v_and_b32 v203, 0xffff0000, v11
  v_rcp_f32 v66, v58
  v_lshlrev_b32 v204, 16, v12
  v_and_b32 v205, 0xffff0000, v12
  v_rcp_f32 v67, v59
  v_lshlrev_b32 v206, 16, v13
  v_and_b32 v207, 0xffff0000, v13
  v_rcp_f32 v68, v60
  v_lshlrev_b32 v208, 16, v14
  v_and_b32 v209, 0xffff0000, v14
  v_rcp_f32 v69, v61
  v_lshlrev_b32 v210, 16, v15
  v_and_b32 v211, 0xffff0000, v15
  v_rcp_f32 v70, v62
  v_lshlrev_b32 v212, 16, v16
  v_and_b32 v213, 0xffff0000, v16
  v_rcp_f32 v71, v63
  v_lshlrev_b32 v214, 16, v17
  v_and_b32 v215, 0xffff0000, v17
  v_pk_add_f32 v[216:217], v[200:201], v[48:49] neg_lo:[0,1] neg_hi:[0,1]
  v_pk_add_f32 v[218:219], v[202:203], v[50:51] neg_lo:[0,1] neg_hi:[0,1]
  v_pk_add_f32 v[220:221], v[204:205], v[52:53] neg_lo:[0,1] neg_hi:[0,1]
  v_pk_add_f32 v[222:223], v[206:207], v[54:55] neg_lo:[0,1] neg_hi:[0,1]
  v_pk_add_f32 v[224:225], v[208:209], v[48:49] neg_lo:[0,1] neg_hi:[0,1]
  v_pk_add_f32 v[226:227], v[210:211], v[50:51] neg_lo:[0,1] neg_hi:[0,1]
  v_pk_add_f32 v[228:229], v[212:213], v[52:53] neg_lo:[0,1] neg_hi:[0,1]
  v_pk_add_f32 v[230:231], v[214:215], v[54:55] neg_lo:[0,1] neg_hi:[0,1]
  v_cvt_pk_bf16_f32 v72, v216, v217
  v_cvt_pk_bf16_f32 v73, v218, v219
  v_cvt_pk_bf16_f32 v74, v220, v221
  v_cvt_pk_bf16_f32 v75, v222, v223
  v_cvt_pk_bf16_f32 v76, v224, v225
  v_cvt_pk_bf16_f32 v77, v226, v227
  v_cvt_pk_bf16_f32 v78, v228, v229
  v_cvt_pk_bf16_f32 v79, v230, v231
  v_lshlrev_b32_e64 v216, 16, v72
  v_and_b32 v217, 0xffff0000, v72
  v_lshlrev_b32_e64 v218, 16, v73
  v_and_b32 v219, 0xffff0000, v73
  v_lshlrev_b32_e64 v220, 16, v74
  v_and_b32 v221, 0xffff0000, v74
  v_lshlrev_b32_e64 v222, 16, v75
  v_and_b32 v223, 0xffff0000, v75
  v_lshlrev_b32_e64 v224, 16, v76
  v_and_b32 v225, 0xffff0000, v76
  v_lshlrev_b32_e64 v226, 16, v77
  v_and_b32 v227, 0xffff0000, v77
  v_lshlrev_b32_e64 v228, 16, v78
  v_and_b32 v229, 0xffff0000, v78
  v_lshlrev_b32_e64 v230, 16, v79
  v_and_b32 v231, 0xffff0000, v79
  v_pk_mul_f32 v[216:217], v[216:217], v[64:65]
  v_pk_mul_f32 v[218:219], v[218:219], v[66:67]
  v_pk_mul_f32 v[220:221], v[220:221], v[68:69]
  v_pk_mul_f32 v[222:223], v[222:223], v[70:71]
  v_pk_mul_f32 v[224:225], v[224:225], v[64:65]
  v_pk_mul_f32 v[226:227], v[226:227], v[66:67]
  v_pk_mul_f32 v[228:229], v[228:229], v[68:69]
  v_pk_mul_f32 v[230:231], v[230:231], v[70:71]
  v_cvt_pk_bf16_f32 v40, v216, v217
  v_cvt_pk_bf16_f32 v41, v218, v219
  v_cvt_pk_bf16_f32 v42, v220, v221
  v_cvt_pk_bf16_f32 v43, v222, v223
  ds_write_b128 v5, v[40:43] offset:4640
  ds_write2_b32 v5, v40, v41 offset0:1 offset1:2
  ds_write2_b32 v5, v42, v43 offset0:3 offset1:4
  v_cvt_pk_bf16_f32 v44, v224, v225
  v_cvt_pk_bf16_f32 v45, v226, v227
  v_cvt_pk_bf16_f32 v46, v228, v229
  v_cvt_pk_bf16_f32 v47, v230, v231
  ds_write_b128 v6, v[44:47] offset:4640
  ds_write2_b32 v6, v44, v45 offset0:1 offset1:2
  ds_write2_b32 v6, v46, v47 offset0:3 offset1:4
  s_waitcnt lgkmcnt(0)
  s_barrier
  ds_read_b128 v[144:147], v9 offset:192
  ds_read_b128 v[148:151], v9 offset:704
  ds_read_b128 v[152:155], v9 offset:1216
  ds_read_b128 v[156:159], v9 offset:1728
  ds_read_b128 v[160:163], v9 offset:2240
  ds_read_b128 v[164:167], v9 offset:2752
  ds_read_b128 v[168:171], v9 offset:3264
  ds_read_b128 v[172:175], v9 offset:3776
  s_waitcnt lgkmcnt(0)
  v_mfma_f32_16x16x32_bf16 v[80:83], v[112:115], v[144:147], 0
  ds_read_b128 v[176:179], v9 offset:128
  v_mfma_f32_16x16x32_bf16 v[84:87], v[112:115], v[148:151], 0
  ds_read_b128 v[180:183], v9 offset:640
  v_mfma_f32_16x16x32_bf16 v[88:91], v[112:115], v[152:155], 0
  ds_read_b128 v[184:187], v9 offset:1152
  v_mfma_f32_16x16x32_bf16 v[92:95], v[112:115], v[156:159], 0
  ds_read_b128 v[188:191], v9 offset:1664
  v_mfma_f32_16x16x32_bf16 v[96:99], v[112:115], v[160:163], 0
  ds_read_b128 v[192:195], v9 offset:2176
  v_mfma_f32_16x16x32_bf16 v[100:103], v[112:115], v[164:167], 0
  ds_read_b128 v[196:199], v9 offset:2688
  v_mfma_f32_16x16x32_bf16 v[104:107], v[112:115], v[168:171], 0
  ds_read_b128 v[72:75], v9 offset:3200
  v_mfma_f32_16x16x32_bf16 v[108:111], v[112:115], v[172:175], 0
  ds_read_b128 v[76:79], v9 offset:3712
  v_mfma_f32_16x16x32_bf16 v[84:87], v[116:119], v[144:147], v[84:87]
  ds_read_b64 v[40:41], v8 offset:3648
  v_mfma_f32_16x16x32_bf16 v[88:91], v[116:119], v[148:151], v[88:91]
  ds_read_b64 v[42:43], v8 offset:3656
  s_cbranch_vccz WG_24
  buffer_load_dwordx4 a[96:99], v18, s[44:47], s15 offen sc1
  s_add_u32 s15, s15, 1024
  buffer_load_dwordx4 a[100:103], v18, s[44:47], s15 offen sc1
  s_add_u32 s15, s15, 1024
  buffer_load_dwordx4 a[104:107], v18, s[44:47], s15 offen sc1
  s_add_u32 s15, s15, 1024
  buffer_load_dwordx4 a[108:111], v18, s[44:47], s15 offen sc1
  s_add_u32 s15, s15, 1024
WG_24:
  v_mfma_f32_16x16x32_bf16 v[92:95], v[116:119], v[152:155], v[92:95]
  ds_read_b64 v[44:45], v8 offset:3136
  v_mfma_f32_16x16x32_bf16 v[96:99], v[116:119], v[156:159], v[96:99]
  ds_read_b64 v[46:47], v8 offset:3144
  v_mfma_f32_16x16x32_bf16 v[100:103], v[116:119], v[160:163], v[100:103]
  ds_read_b64 v[48:49], v8 offset:2624
  v_mfma_f32_16x16x32_bf16 v[104:107], v[116:119], v[164:167], v[104:107]
  ds_read_b64 v[50:51], v8 offset:2632
  v_mfma_f32_16x16x32_bf16 v[108:111], v[116:119], v[168:171], v[108:111]
  ds_read_b64 v[52:53], v8 offset:2112
  v_mfma_f32_16x16x32_bf16 v[88:91], v[120:123], v[144:147], v[88:91]
  ds_read_b64 v[54:55], v8 offset:2120
  v_mfma_f32_16x16x32_bf16 v[92:95], v[120:123], v[148:151], v[92:95]
  ds_read_b64 v[56:57], v8 offset:1600
  v_mfma_f32_16x16x32_bf16 v[96:99], v[120:123], v[152:155], v[96:99]
  ds_read_b64 v[58:59], v8 offset:1608
  v_mfma_f32_16x16x32_bf16 v[100:103], v[120:123], v[156:159], v[100:103]
  ds_read_b64 v[60:61], v8 offset:1088
  v_mfma_f32_16x16x32_bf16 v[104:107], v[120:123], v[160:163], v[104:107]
  ds_read_b64 v[62:63], v8 offset:1096
  v_mfma_f32_16x16x32_bf16 v[108:111], v[120:123], v[164:167], v[108:111]
  ds_read_b64 v[64:65], v8 offset:576
  v_mfma_f32_16x16x32_bf16 v[92:95], v[124:127], v[144:147], v[92:95]
  ds_read_b64 v[66:67], v8 offset:584
  v_mfma_f32_16x16x32_bf16 v[96:99], v[124:127], v[148:151], v[96:99]
  ds_read_b64 v[68:69], v8 offset:64
  v_mfma_f32_16x16x32_bf16 v[100:103], v[124:127], v[152:155], v[100:103]
  ds_read_b64 v[70:71], v8 offset:72
  v_mfma_f32_16x16x32_bf16 v[104:107], v[124:127], v[156:159], v[104:107]
  v_mfma_f32_16x16x32_bf16 v[108:111], v[124:127], v[160:163], v[108:111]
  v_mfma_f32_16x16x32_bf16 v[96:99], v[128:131], v[144:147], v[96:99]
  v_mfma_f32_16x16x32_bf16 v[100:103], v[128:131], v[148:151], v[100:103]
  v_mfma_f32_16x16x32_bf16 v[104:107], v[128:131], v[152:155], v[104:107]
  v_mfma_f32_16x16x32_bf16 v[108:111], v[128:131], v[156:159], v[108:111]
  s_cbranch_vccz WG_25
  s_nop 0
  buffer_load_dwordx4 a[112:115], v18, s[44:47], s15 offen sc1
  s_add_u32 s15, s15, 1024
  buffer_load_dwordx4 a[116:119], v18, s[44:47], s15 offen sc1
  s_add_u32 s15, s15, 1024
  buffer_load_dwordx4 a[120:123], v18, s[44:47], s15 offen sc1
  s_add_u32 s15, s15, 1024
  buffer_load_dwordx4 a[124:127], v18, s[44:47], s15 offen sc1
  s_add_u32 s15, s15, 508928
WG_25:
  v_mfma_f32_16x16x32_bf16 v[100:103], v[132:135], v[144:147], v[100:103]
  v_mfma_f32_16x16x32_bf16 v[104:107], v[132:135], v[148:151], v[104:107]
  v_mfma_f32_16x16x32_bf16 v[108:111], v[132:135], v[152:155], v[108:111]
  v_mfma_f32_16x16x32_bf16 v[104:107], v[136:139], v[144:147], v[104:107]
  v_mfma_f32_16x16x32_bf16 v[108:111], v[136:139], v[148:151], v[108:111]
  v_mfma_f32_16x16x32_bf16 v[108:111], v[140:143], v[144:147], v[108:111]
  s_waitcnt lgkmcnt(0)
  v_mfma_f32_16x16x32_bf16 v[80:83], a[192:195], v[176:179], v[80:83]
  ds_read_b128 v[144:147], v9 offset:64
  v_mfma_f32_16x16x32_bf16 v[84:87], a[192:195], v[180:183], v[84:87]
  ds_read_b128 v[148:151], v9 offset:576
  v_mfma_f32_16x16x32_bf16 v[88:91], a[192:195], v[184:187], v[88:91]
  ds_read_b128 v[152:155], v9 offset:1088
  v_mfma_f32_16x16x32_bf16 v[92:95], a[192:195], v[188:191], v[92:95]
  ds_read_b128 v[156:159], v9 offset:1600
  v_mfma_f32_16x16x32_bf16 v[96:99], a[192:195], v[192:195], v[96:99]
  ds_read_b128 v[160:163], v9 offset:2112
  v_mfma_f32_16x16x32_bf16 v[100:103], a[192:195], v[196:199], v[100:103]
  ds_read_b128 v[164:167], v9 offset:2624
  v_mfma_f32_16x16x32_bf16 v[104:107], a[192:195], v[72:75], v[104:107]
  ds_read_b128 v[168:171], v9 offset:3136
  v_mfma_f32_16x16x32_bf16 v[108:111], a[192:195], v[76:79], v[108:111]
  ds_read_b128 v[172:175], v9 offset:3648
  v_mfma_f32_16x16x32_bf16 v[84:87], a[196:199], v[176:179], v[84:87]
  v_mfma_f32_16x16x32_bf16 v[88:91], a[196:199], v[180:183], v[88:91]
  v_mfma_f32_16x16x32_bf16 v[92:95], a[196:199], v[184:187], v[92:95]
  v_mfma_f32_16x16x32_bf16 v[96:99], a[196:199], v[188:191], v[96:99]
  v_mfma_f32_16x16x32_bf16 v[100:103], a[196:199], v[192:195], v[100:103]
  v_mfma_f32_16x16x32_bf16 v[104:107], a[196:199], v[196:199], v[104:107]
  s_cbranch_vccz WG_26
  buffer_load_dwordx4 a[128:131], v18, s[44:47], s15 offen sc1
  s_add_u32 s15, s15, 1024
  buffer_load_dwordx4 a[132:135], v18, s[44:47], s15 offen sc1
  s_add_u32 s15, s15, 1024
  buffer_load_dwordx4 a[136:139], v18, s[44:47], s15 offen sc1
  s_add_u32 s15, s15, 1024
  buffer_load_dwordx4 a[140:143], v18, s[44:47], s15 offen sc1
  s_add_u32 s15, s15, 1024
WG_26:
  v_mfma_f32_16x16x32_bf16 v[108:111], a[196:199], v[72:75], v[108:111]
  v_mfma_f32_16x16x32_bf16 v[88:91], a[200:203], v[176:179], v[88:91]
  v_mfma_f32_16x16x32_bf16 v[92:95], a[200:203], v[180:183], v[92:95]
  v_mfma_f32_16x16x32_bf16 v[96:99], a[200:203], v[184:187], v[96:99]
  v_mfma_f32_16x16x32_bf16 v[100:103], a[200:203], v[188:191], v[100:103]
  v_mfma_f32_16x16x32_bf16 v[104:107], a[200:203], v[192:195], v[104:107]
  v_mfma_f32_16x16x32_bf16 v[108:111], a[200:203], v[196:199], v[108:111]
  v_mfma_f32_16x16x32_bf16 v[92:95], a[204:207], v[176:179], v[92:95]
  v_mfma_f32_16x16x32_bf16 v[96:99], a[204:207], v[180:183], v[96:99]
  v_mfma_f32_16x16x32_bf16 v[100:103], a[204:207], v[184:187], v[100:103]
  v_mfma_f32_16x16x32_bf16 v[104:107], a[204:207], v[188:191], v[104:107]
  v_mfma_f32_16x16x32_bf16 v[108:111], a[204:207], v[192:195], v[108:111]
  v_mfma_f32_16x16x32_bf16 v[96:99], a[208:211], v[176:179], v[96:99]
  v_mfma_f32_16x16x32_bf16 v[100:103], a[208:211], v[180:183], v[100:103]
  v_mfma_f32_16x16x32_bf16 v[104:107], a[208:211], v[184:187], v[104:107]
  v_mfma_f32_16x16x32_bf16 v[108:111], a[208:211], v[188:191], v[108:111]
  v_mfma_f32_16x16x32_bf16 v[100:103], a[212:215], v[176:179], v[100:103]
  v_mfma_f32_16x16x32_bf16 v[104:107], a[212:215], v[180:183], v[104:107]
  v_mfma_f32_16x16x32_bf16 v[108:111], a[212:215], v[184:187], v[108:111]
  v_mfma_f32_16x16x32_bf16 v[104:107], a[216:219], v[176:179], v[104:107]
  s_cbranch_vccz WG_27
  s_nop 0
  buffer_load_dwordx4 a[144:147], v18, s[44:47], s15 offen sc1
  s_add_u32 s15, s15, 1024
  buffer_load_dwordx4 a[148:151], v18, s[44:47], s15 offen sc1
  s_add_u32 s15, s15, 1024
  buffer_load_dwordx4 a[152:155], v18, s[44:47], s15 offen sc1
  s_add_u32 s15, s15, 1024
  buffer_load_dwordx4 a[156:159], v18, s[44:47], s15 offen sc1
  s_add_u32 s15, s15, 1024
WG_27:
  v_mfma_f32_16x16x32_bf16 v[108:111], a[216:219], v[180:183], v[108:111]
  v_mfma_f32_16x16x32_bf16 v[108:111], a[220:223], v[176:179], v[108:111]
  s_waitcnt lgkmcnt(0)
  v_mfma_f32_16x16x32_bf16 v[80:83], v[40:43], v[144:147], v[80:83]
  ds_read_b128 v[176:179], v9 offset:0
  v_mfma_f32_16x16x32_bf16 v[84:87], v[40:43], v[148:151], v[84:87]
  ds_read_b128 v[180:183], v9 offset:512
  v_mfma_f32_16x16x32_bf16 v[88:91], v[40:43], v[152:155], v[88:91]
  ds_read_b128 v[184:187], v9 offset:1024
  v_mfma_f32_16x16x32_bf16 v[92:95], v[40:43], v[156:159], v[92:95]
  ds_read_b128 v[188:191], v9 offset:1536
  v_mfma_f32_16x16x32_bf16 v[96:99], v[40:43], v[160:163], v[96:99]
  ds_read_b128 v[192:195], v9 offset:2048
  v_mfma_f32_16x16x32_bf16 v[100:103], v[40:43], v[164:167], v[100:103]
  ds_read_b128 v[196:199], v9 offset:2560
  v_mfma_f32_16x16x32_bf16 v[104:107], v[40:43], v[168:171], v[104:107]
  ds_read_b128 v[72:75], v9 offset:3072
  v_mfma_f32_16x16x32_bf16 v[108:111], v[40:43], v[172:175], v[108:111]
  ds_read_b128 v[76:79], v9 offset:3584
  v_mfma_f32_16x16x32_bf16 v[84:87], v[44:47], v[144:147], v[84:87]
  v_mfma_f32_16x16x32_bf16 v[88:91], v[44:47], v[148:151], v[88:91]
  v_mfma_f32_16x16x32_bf16 v[92:95], v[44:47], v[152:155], v[92:95]
  v_mfma_f32_16x16x32_bf16 v[96:99], v[44:47], v[156:159], v[96:99]
  v_mfma_f32_16x16x32_bf16 v[100:103], v[44:47], v[160:163], v[100:103]
  v_mfma_f32_16x16x32_bf16 v[104:107], v[44:47], v[164:167], v[104:107]
  v_mfma_f32_16x16x32_bf16 v[108:111], v[44:47], v[168:171], v[108:111]
  v_mfma_f32_16x16x32_bf16 v[88:91], v[48:51], v[144:147], v[88:91]
  v_mfma_f32_16x16x32_bf16 v[92:95], v[48:51], v[148:151], v[92:95]
  v_mfma_f32_16x16x32_bf16 v[96:99], v[48:51], v[152:155], v[96:99]
  s_cbranch_vccz WG_28
  buffer_load_dwordx4 a[160:163], v18, s[44:47], s15 offen sc1
  s_add_u32 s15, s15, 1024
  buffer_load_dwordx4 a[164:167], v18, s[44:47], s15 offen sc1
  s_add_u32 s15, s15, 1024
  buffer_load_dwordx4 a[168:171], v18, s[44:47], s15 offen sc1
  s_add_u32 s15, s15, 1024
  buffer_load_dwordx4 a[172:175], v18, s[44:47], s15 offen sc1
  s_add_u32 s15, s15, 1024
WG_28:
  v_mfma_f32_16x16x32_bf16 v[100:103], v[48:51], v[156:159], v[100:103]
  v_mfma_f32_16x16x32_bf16 v[104:107], v[48:51], v[160:163], v[104:107]
  v_mfma_f32_16x16x32_bf16 v[108:111], v[48:51], v[164:167], v[108:111]
  v_mfma_f32_16x16x32_bf16 v[92:95], v[52:55], v[144:147], v[92:95]
  v_mfma_f32_16x16x32_bf16 v[96:99], v[52:55], v[148:151], v[96:99]
  v_mfma_f32_16x16x32_bf16 v[100:103], v[52:55], v[152:155], v[100:103]
  v_mfma_f32_16x16x32_bf16 v[104:107], v[52:55], v[156:159], v[104:107]
  v_mfma_f32_16x16x32_bf16 v[108:111], v[52:55], v[160:163], v[108:111]
  v_mfma_f32_16x16x32_bf16 v[96:99], v[56:59], v[144:147], v[96:99]
  v_mfma_f32_16x16x32_bf16 v[100:103], v[56:59], v[148:151], v[100:103]
  v_mfma_f32_16x16x32_bf16 v[104:107], v[56:59], v[152:155], v[104:107]
  v_mfma_f32_16x16x32_bf16 v[108:111], v[56:59], v[156:159], v[108:111]
  v_mfma_f32_16x16x32_bf16 v[100:103], v[60:63], v[144:147], v[100:103]
  v_mfma_f32_16x16x32_bf16 v[104:107], v[60:63], v[148:151], v[104:107]
  v_mfma_f32_16x16x32_bf16 v[108:111], v[60:63], v[152:155], v[108:111]
  v_mfma_f32_16x16x32_bf16 v[104:107], v[64:67], v[144:147], v[104:107]
  v_mfma_f32_16x16x32_bf16 v[108:111], v[64:67], v[148:151], v[108:111]
  v_mfma_f32_16x16x32_bf16 v[108:111], v[68:71], v[144:147], v[108:111]
  s_waitcnt lgkmcnt(0)
  v_mfma_f32_16x16x32_bf16 v[80:83], a[224:227], v[176:179], v[80:83]
  v_mfma_f32_16x16x32_bf16 v[84:87], a[224:227], v[180:183], v[84:87]
  s_cbranch_vccz WG_29
  buffer_load_dwordx4 a[176:179], v18, s[44:47], s15 offen sc1
  s_add_u32 s15, s15, 1024
  buffer_load_dwordx4 a[180:183], v18, s[44:47], s15 offen sc1
  s_add_u32 s15, s15, 1024
  buffer_load_dwordx4 a[184:187], v18, s[44:47], s15 offen sc1
  s_add_u32 s15, s15, 1024
  buffer_load_dwordx4 a[188:191], v18, s[44:47], s15 offen sc1
  s_add_u32 s15, s15, 508928
WG_29:
  v_mfma_f32_16x16x32_bf16 v[88:91], a[224:227], v[184:187], v[88:91]
  v_mfma_f32_16x16x32_bf16 v[92:95], a[224:227], v[188:191], v[92:95]
  v_mfma_f32_16x16x32_bf16 v[96:99], a[224:227], v[192:195], v[96:99]
  v_mfma_f32_16x16x32_bf16 v[100:103], a[224:227], v[196:199], v[100:103]
  v_mfma_f32_16x16x32_bf16 v[104:107], a[224:227], v[72:75], v[104:107]
  v_mfma_f32_16x16x32_bf16 v[108:111], a[224:227], v[76:79], v[108:111]
  v_mfma_f32_16x16x32_bf16 v[84:87], a[228:231], v[176:179], v[84:87]
  v_mfma_f32_16x16x32_bf16 v[88:91], a[228:231], v[180:183], v[88:91]
  v_mfma_f32_16x16x32_bf16 v[92:95], a[228:231], v[184:187], v[92:95]
  v_mfma_f32_16x16x32_bf16 v[96:99], a[228:231], v[188:191], v[96:99]
  v_mfma_f32_16x16x32_bf16 v[100:103], a[228:231], v[192:195], v[100:103]
  v_mfma_f32_16x16x32_bf16 v[104:107], a[228:231], v[196:199], v[104:107]
  v_mfma_f32_16x16x32_bf16 v[108:111], a[228:231], v[72:75], v[108:111]
  v_mfma_f32_16x16x32_bf16 v[88:91], a[232:235], v[176:179], v[88:91]
  v_mfma_f32_16x16x32_bf16 v[92:95], a[232:235], v[180:183], v[92:95]
  v_mfma_f32_16x16x32_bf16 v[96:99], a[232:235], v[184:187], v[96:99]
  v_mfma_f32_16x16x32_bf16 v[100:103], a[232:235], v[188:191], v[100:103]
  v_mfma_f32_16x16x32_bf16 v[104:107], a[232:235], v[192:195], v[104:107]
  v_mfma_f32_16x16x32_bf16 v[108:111], a[232:235], v[196:199], v[108:111]
  v_mfma_f32_16x16x32_bf16 v[92:95], a[236:239], v[176:179], v[92:95]
  v_mfma_f32_16x16x32_bf16 v[96:99], a[236:239], v[180:183], v[96:99]
  v_mfma_f32_16x16x32_bf16 v[100:103], a[236:239], v[184:187], v[100:103]
  v_mfma_f32_16x16x32_bf16 v[104:107], a[236:239], v[188:191], v[104:107]
  v_mfma_f32_16x16x32_bf16 v[108:111], a[236:239], v[192:195], v[108:111]
  v_mfma_f32_16x16x32_bf16 v[96:99], a[240:243], v[176:179], v[96:99]
  v_mfma_f32_16x16x32_bf16 v[100:103], a[240:243], v[180:183], v[100:103]
  v_mfma_f32_16x16x32_bf16 v[104:107], a[240:243], v[184:187], v[104:107]
  v_mfma_f32_16x16x32_bf16 v[108:111], a[240:243], v[188:191], v[108:111]
  v_mfma_f32_16x16x32_bf16 v[100:103], a[244:247], v[176:179], v[100:103]
  v_mfma_f32_16x16x32_bf16 v[104:107], a[244:247], v[180:183], v[104:107]
  v_mfma_f32_16x16x32_bf16 v[108:111], a[244:247], v[184:187], v[108:111]
  v_mfma_f32_16x16x32_bf16 v[104:107], a[248:251], v[176:179], v[104:107]
  v_mfma_f32_16x16x32_bf16 v[108:111], a[248:251], v[180:183], v[108:111]
  v_mfma_f32_16x16x32_bf16 v[108:111], a[252:255], v[176:179], v[108:111]
  s_cbranch_vccz WB_30
  s_nop 0
  s_add_u32 s13, s79, 4096
  buffer_load_dwordx4 a[16:19], v18, s[44:47], s13 offen sc1
  s_add_u32 s13, s79, 5120
  buffer_load_dwordx4 a[20:23], v18, s[44:47], s13 offen sc1
  s_add_u32 s13, s79, 6144
  buffer_load_dwordx4 a[24:27], v18, s[44:47], s13 offen sc1
  s_add_u32 s13, s79, 7168
  buffer_load_dwordx4 a[28:31], v18, s[44:47], s13 offen sc1
  s_add_u32 s13, s79, 8192
  buffer_load_dwordx4 a[32:35], v18, s[44:47], s13 offen sc1
  s_add_u32 s13, s79, 9216
  buffer_load_dwordx4 a[36:39], v18, s[44:47], s13 offen sc1
  s_add_u32 s13, s79, 10240
  buffer_load_dwordx4 a[40:43], v18, s[44:47], s13 offen sc1
  s_add_u32 s13, s79, 11264
  buffer_load_dwordx4 a[44:47], v18, s[44:47], s13 offen sc1
  s_add_u32 s13, s79, 12288
  buffer_load_dwordx4 a[48:51], v18, s[44:47], s13 offen sc1
  s_add_u32 s13, s79, 13312
  buffer_load_dwordx4 a[52:55], v18, s[44:47], s13 offen sc1
  s_add_u32 s13, s79, 14336
  buffer_load_dwordx4 a[56:59], v18, s[44:47], s13 offen sc1
  s_add_u32 s13, s79, 15360
  buffer_load_dwordx4 a[60:63], v18, s[44:47], s13 offen sc1
WB_30:
  ds_write_b64 v2, v[80:81] offset:0
  ds_write_b64 v2, v[82:83] offset:16
  ds_write_b64 v2, v[84:85] offset:1152
  ds_write_b64 v2, v[86:87] offset:1168
  ds_write_b64 v2, v[88:89] offset:2304
  ds_write_b64 v2, v[90:91] offset:2320
  ds_write_b64 v2, v[92:93] offset:3456
  ds_write_b64 v2, v[94:95] offset:3472
  ds_write_b64 v2, v[96:97] offset:4608
  ds_write_b64 v2, v[98:99] offset:4624
  ds_write_b64 v2, v[100:101] offset:5760
  ds_write_b64 v2, v[102:103] offset:5776
  ds_write_b64 v2, v[104:105] offset:6912
  ds_write_b64 v2, v[106:107] offset:6928
  ds_write_b64 v2, v[108:109] offset:8064
  ds_write_b64 v2, v[110:111] offset:8080
  s_waitcnt lgkmcnt(0)
  s_barrier
  ds_read_b128 v[112:115], v7 offset:0
  ds_read_b128 v[116:119], v7 offset:16
  ds_read_b128 v[128:131], v7 offset:18432
  ds_read_b128 v[132:135], v7 offset:18448
  ds_read_b128 v[120:123], v7 offset:9216
  ds_read_b128 v[124:127], v7 offset:9232
  ds_read_b128 v[136:139], v7 offset:27648
  ds_read_b128 v[140:143], v7 offset:27664
  v_subrev_u32 v3, s72, v3
  v_add_u32 v3, s73, v3
  v_add_u32 v1, 4096, v3
  s_waitcnt lgkmcnt(4)
  s_nop 0
  v_pk_add_f32 v[112:113], v[112:113], v[128:129]
  v_pk_add_f32 v[114:115], v[114:115], v[130:131]
  v_pk_add_f32 v[116:117], v[116:117], v[132:133]
  v_pk_add_f32 v[118:119], v[118:119], v[134:135]
  v_pk_fma_f32 v[112:113], v[216:217], v[244:245], v[112:113] op_sel_hi:[1,0,1]
  v_pk_fma_f32 v[114:115], v[218:219], v[244:245], v[114:115] op_sel_hi:[1,0,1]
  v_pk_fma_f32 v[116:117], v[220:221], v[244:245], v[116:117] op_sel_hi:[1,0,1]
  v_pk_fma_f32 v[118:119], v[222:223], v[244:245], v[118:119] op_sel_hi:[1,0,1]
  v_pk_add_f32 v[112:113], v[112:113], v[200:201]
  v_pk_add_f32 v[114:115], v[114:115], v[202:203]
  v_pk_add_f32 v[116:117], v[116:117], v[204:205]
  v_pk_add_f32 v[118:119], v[118:119], v[206:207]
  v_cvt_pk_bf16_f32 v80, v112, v113
  v_cvt_pk_bf16_f32 v81, v114, v115
  v_cvt_pk_bf16_f32 v82, v116, v117
  v_cvt_pk_bf16_f32 v83, v118, v119
  buffer_store_dwordx4 v[80:83], v3, s[44:47], 0 offen sc1
  s_waitcnt lgkmcnt(0)
  s_nop 0
  v_pk_add_f32 v[120:121], v[120:121], v[136:137]
  v_pk_add_f32 v[122:123], v[122:123], v[138:139]
  v_pk_add_f32 v[124:125], v[124:125], v[140:141]
  v_pk_add_f32 v[126:127], v[126:127], v[142:143]
  v_pk_fma_f32 v[120:121], v[224:225], v[246:247], v[120:121] op_sel_hi:[1,0,1]
  v_pk_fma_f32 v[122:123], v[226:227], v[246:247], v[122:123] op_sel_hi:[1,0,1]
  v_pk_fma_f32 v[124:125], v[228:229], v[246:247], v[124:125] op_sel_hi:[1,0,1]
  v_pk_fma_f32 v[126:127], v[230:231], v[246:247], v[126:127] op_sel_hi:[1,0,1]
  v_pk_add_f32 v[120:121], v[120:121], v[208:209]
  v_pk_add_f32 v[122:123], v[122:123], v[210:211]
  v_pk_add_f32 v[124:125], v[124:125], v[212:213]
  v_pk_add_f32 v[126:127], v[126:127], v[214:215]
  v_cvt_pk_bf16_f32 v84, v120, v121
  v_cvt_pk_bf16_f32 v85, v122, v123
  v_cvt_pk_bf16_f32 v86, v124, v125
  v_cvt_pk_bf16_f32 v87, v126, v127
  buffer_store_dwordx4 v[84:87], v1, s[44:47], 0 offen sc1
  s_waitcnt vmcnt(0) lgkmcnt(0)
  s_barrier
  s_add_u32 s7, s7, 16
  s_cmp_eq_u32 s3, 0
  s_cbranch_scc0 ARR_31
  s_mov_b64 exec, 1
  v_mov_b32_e64 v232, 1
  buffer_atomic_add v232, v239, s[44:47], 0 offen sc0 sc1
  s_mov_b64 exec, -1
ARR_31:
  s_mov_b32 s72, s73
  s_cmp_eq_u32 s6, 0
  s_cbranch_scc0 WS_32
  v_mov_b32 v16, s64
  v_mov_b32 v17, s64
  v_mov_b32 v18, s64
  v_mov_b32_e64 v19, s64
  s_nop 1
  v_mfma_f32_16x16x32_bf16 v[24:27], v[16:19], a[64:67], 0
  v_mfma_f32_16x16x32_bf16 v[28:31], v[16:19], a[128:131], 0
  v_mfma_f32_16x16x32_bf16 v[24:27], v[16:19], a[68:71], v[24:27]
  v_mfma_f32_16x16x32_bf16 v[28:31], v[16:19], a[132:135], v[28:31]
  v_mfma_f32_16x16x32_bf16 v[24:27], v[16:19], a[72:75], v[24:27]
  v_mfma_f32_16x16x32_bf16 v[28:31], v[16:19], a[136:139], v[28:31]
  v_mfma_f32_16x16x32_bf16 v[24:27], v[16:19], a[76:79], v[24:27]
  v_mfma_f32_16x16x32_bf16 v[28:31], v[16:19], a[140:143], v[28:31]
  v_mfma_f32_16x16x32_bf16 v[24:27], v[16:19], a[80:83], v[24:27]
  v_mfma_f32_16x16x32_bf16 v[28:31], v[16:19], a[144:147], v[28:31]
  v_mfma_f32_16x16x32_bf16 v[24:27], v[16:19], a[84:87], v[24:27]
  v_mfma_f32_16x16x32_bf16 v[28:31], v[16:19], a[148:151], v[28:31]
  v_mfma_f32_16x16x32_bf16 v[24:27], v[16:19], a[88:91], v[24:27]
  v_mfma_f32_16x16x32_bf16 v[28:31], v[16:19], a[152:155], v[28:31]
  v_mfma_f32_16x16x32_bf16 v[24:27], v[16:19], a[92:95], v[24:27]
  v_mfma_f32_16x16x32_bf16 v[28:31], v[16:19], a[156:159], v[28:31]
  v_mfma_f32_16x16x32_bf16 v[24:27], v[16:19], a[96:99], v[24:27]
  v_mfma_f32_16x16x32_bf16 v[28:31], v[16:19], a[160:163], v[28:31]
  v_mfma_f32_16x16x32_bf16 v[24:27], v[16:19], a[100:103], v[24:27]
  v_mfma_f32_16x16x32_bf16 v[28:31], v[16:19], a[164:167], v[28:31]
  v_mfma_f32_16x16x32_bf16 v[24:27], v[16:19], a[104:107], v[24:27]
  v_mfma_f32_16x16x32_bf16 v[28:31], v[16:19], a[168:171], v[28:31]
  v_mfma_f32_16x16x32_bf16 v[24:27], v[16:19], a[108:111], v[24:27]
  v_mfma_f32_16x16x32_bf16 v[28:31], v[16:19], a[172:175], v[28:31]
  v_mfma_f32_16x16x32_bf16 v[24:27], v[16:19], a[112:115], v[24:27]
  v_mfma_f32_16x16x32_bf16 v[28:31], v[16:19], a[176:179], v[28:31]
  v_mfma_f32_16x16x32_bf16 v[24:27], v[16:19], a[116:119], v[24:27]
  v_mfma_f32_16x16x32_bf16 v[28:31], v[16:19], a[180:183], v[28:31]
  v_mfma_f32_16x16x32_bf16 v[24:27], v[16:19], a[120:123], v[24:27]
  v_mfma_f32_16x16x32_bf16 v[28:31], v[16:19], a[184:187], v[28:31]
  v_mfma_f32_16x16x32_bf16 v[24:27], v[16:19], a[124:127], v[24:27]
  v_mfma_f32_16x16x32_bf16 v[28:31], v[16:19], a[188:191], v[28:31]
  s_nop 6
  v_mov_b32 v254, v24
  v_mov_b32 v252, v28
WS_32:
  v_lshrrev_b32 v10, 3, v255
  v_lshlrev_b32_e64 v10, 12, v10
  v_bfe_u32 v11, v255, 1, 2
  v_bfe_u32 v12, v255, 4, 1
  s_and_b32 s8, s3, 1
  s_lshl_b32 s8, s8, 1
  v_or_b32 v12, s8, v12
  v_xor_b32 v11, v11, v12
  v_lshl_add_u32 v10, v11, 5, v10
  v_and_b32_e64 v11, 1, v255
  v_lshl_add_u32 v10, v11, 4, v10
  s_lshl_b32 s8, s4, 7
  v_add_u32_e64 v10, s8, v10
  s_lshl_b32 s15, s3, 15
  s_add_u32 s15, s15, s72
  s_lshl_b32 s14, s3, 10
  s_add_u32 s14, s14, 82432
  v_lshrrev_b32_e64 v12, 2, v243
  v_lshl_add_u32 v13, v242, 3, v12
  v_lshlrev_b32 v13, 7, v13
  v_and_b32 v14, 3, v243
  v_lshl_add_u32 v13, v14, 3, v13
  v_add_u32 v13, 82432, v13
  v_lshrrev_b32 v12, 1, v12
  v_and_b32 v14, 1, v242
  v_lshl_or_b32 v12, v14, 1, v12
  v_xor_b32 v12, s3, v12
  v_xor_b32 v14, 0, v12
  v_lshl_add_u32 v4, v14, 5, v13
  v_xor_b32_e64 v14, 1, v12
  v_lshl_add_u32 v5, v14, 5, v13
  v_xor_b32_e64 v14, 2, v12
  v_lshl_add_u32 v6, v14, 5, v13
  v_xor_b32_e64 v14, 3, v12
  v_lshl_add_u32 v7, v14, 5, v13
  v_mov_b32 v104, s64
  v_mov_b32 v105, s64
  v_mov_b32 v106, s64
  v_mov_b32 v107, s64
  s_mov_b32 s66, 0x358637bd
  s_mov_b32 s67, 0x3fb8aa3b
  v_mov_b32 v112, s66
  v_mov_b32 v113, s66
  v_mov_b32 v114, s67
  v_mov_b32 v115, s67
  s_cmp_eq_u32 s3, 0
  s_cbranch_scc0 WT_33
  s_mov_b64 exec, 0xffff
  s_mov_b32 s78, 0
  s_cmp_eq_u32 s6, 0
  s_cselect_b32 s9, 2, 1
  s_waitcnt vmcnt(0)
  v_readfirstlane_b32 s8, v232
  s_nop 3
  s_and_b32 s8, s8, 15
  s_sub_u32 s8, 15, s8
  s_mul_i32 s8, s8, s9
  s_add_u32 s8, s8, 0
AD_37:
  s_sleep 1
  s_sub_u32 s8, s8, 1
  s_cmp_gt_i32 s8, 0
  s_cbranch_scc1 AD_37
POLL_34:
  buffer_load_dword v236, v238, s[44:47], 0 offen offset:0 sc1
  s_add_u32 s78, s78, 1
  s_waitcnt vmcnt(0)
  v_cmp_gt_u32 vcc, s7, v236
  s_nop 4
  s_cbranch_vccz PD_35
  s_sleep 4
  s_cmp_lt_u32 s78, 0x200000
  s_cbranch_scc1 POLL_34
PD_35:
  s_mov_b64 exec, -1
WT_33:
  s_barrier
  s_mov_b32 m0, s14
  s_add_u32 s14, s14, 4096
  buffer_load_dwordx4 v10, s[44:47], s15 offen sc1 lds
  s_add_u32 s15, s15, 131072
  s_mov_b32 m0, s14
  s_add_u32 s14, s14, 4096
  buffer_load_dwordx4 v10, s[44:47], s15 offen sc1 lds
  s_add_u32 s15, s15, 131072
  s_mov_b32 m0, s14
  s_add_u32 s14, s14, 4096
  buffer_load_dwordx4 v10, s[44:47], s15 offen sc1 lds
  s_add_u32 s15, s15, 131072
  s_mov_b32 m0, s14
  s_add_u32 s14, s14, 4096
  buffer_load_dwordx4 v10, s[44:47], s15 offen sc1 lds
  s_add_u32 s15, s15, 131072
  s_mov_b32 m0, s14
  s_add_u32 s14, s14, 4096
  buffer_load_dwordx4 v10, s[44:47], s15 offen sc1 lds
  s_add_u32 s15, s15, 131072
  s_mov_b32 m0, s14
  s_add_u32 s14, s14, 4096
  buffer_load_dwordx4 v10, s[44:47], s15 offen sc1 lds
  s_add_u32 s15, s15, 131072
  s_mov_b32 m0, s14
  s_add_u32 s14, s14, 4096
  buffer_load_dwordx4 v10, s[44:47], s15 offen sc1 lds
  s_add_u32 s15, s15, 131072
  s_mov_b32 m0, s14
  s_add_u32 s14, s14, 4096
  buffer_load_dwordx4 v10, s[44:47], s15 offen sc1 lds
  s_add_u32 s15, s15, 131072
  s_mov_b32 m0, s14
  s_add_u32 s14, s14, 4096
  buffer_load_dwordx4 v10, s[44:47], s15 offen sc1 lds
  s_add_u32 s15, s15, 131072
  s_mov_b32 m0, s14
  s_add_u32 s14, s14, 4096
  buffer_load_dwordx4 v10, s[44:47], s15 offen sc1 lds
  s_add_u32 s15, s15, 131072
  s_mov_b32 m0, s14
  s_add_u32 s14, s14, 4096
  buffer_load_dwordx4 v10, s[44:47], s15 offen sc1 lds
  s_add_u32 s15, s15, 131072
  s_mov_b32 m0, s14
  s_add_u32 s14, s14, 4096
  buffer_load_dwordx4 v10, s[44:47], s15 offen sc1 lds
  s_add_u32 s15, s15, 131072
  s_lshl_b32 s84, s5, 16
  s_lshl_b32 s8, s3, 14
  s_add_u32 s84, s84, s8
  s_add_u32 s84, s84, 15204352
  s_add_u32 s85, s8, 0
  v_lshlrev_b32 v111, 4, v255
  s_waitcnt vmcnt(10)
  s_barrier
  ds_read_b64_tr_b16 v[72:73], v4 offset:0
  ds_read_b64_tr_b16 v[74:75], v4 offset:512
  ds_read_b64_tr_b16 v[76:77], v5 offset:0
  ds_read_b64_tr_b16 v[78:79], v5 offset:512
  ds_read_b64_tr_b16 v[80:81], v6 offset:0
  ds_read_b64_tr_b16 v[82:83], v6 offset:512
  ds_read_b64_tr_b16 v[84:85], v7 offset:0
  ds_read_b64_tr_b16 v[86:87], v7 offset:512
  ds_read_b64_tr_b16 v[200:201], v4 offset:0
  ds_read_b64_tr_b16 v[202:203], v4 offset:512
  s_waitcnt lgkmcnt(0)
  s_waitcnt vmcnt(9)
  s_barrier
  s_nop 0
  v_mfma_f32_16x16x32_bf16 v[16:19], v[72:75], a[64:67], 0
  ds_read_b64_tr_b16 v[88:89], v4 offset:4096
  ds_read_b64_tr_b16 v[90:91], v4 offset:4608
  v_mfma_f32_16x16x32_bf16 v[32:35], v[72:75], a[128:131], 0
  ds_read_b64_tr_b16 v[92:93], v5 offset:4096
  ds_read_b64_tr_b16 v[94:95], v5 offset:4608
  v_mfma_f32_16x16x32_bf16 v[20:23], v[76:79], a[64:67], 0
  ds_read_b64_tr_b16 v[96:97], v6 offset:4096
  ds_read_b64_tr_b16 v[98:99], v6 offset:4608
  v_mfma_f32_16x16x32_bf16 v[36:39], v[76:79], a[128:131], 0
  ds_read_b64_tr_b16 v[100:101], v7 offset:4096
  ds_read_b64_tr_b16 v[102:103], v7 offset:4608
  v_mfma_f32_16x16x32_bf16 v[24:27], v[80:83], a[64:67], 0
  ds_read_b64_tr_b16 v[208:209], v4 offset:4096
  ds_read_b64_tr_b16 v[210:211], v4 offset:4608
  v_mfma_f32_16x16x32_bf16 v[40:43], v[80:83], a[128:131], 0
  ds_read_b64_tr_b16 v[212:213], v4 offset:8192
  ds_read_b64_tr_b16 v[214:215], v4 offset:8704
  v_mfma_f32_16x16x32_bf16 v[28:31], v[84:87], a[64:67], 0
  s_mov_b32 m0, s14
  s_nop 0
  s_add_u32 s14, s14, 4096
  v_mfma_f32_16x16x32_bf16 v[44:47], v[84:87], a[128:131], 0
  buffer_load_dwordx4 v10, s[44:47], s15 offen sc1 lds
  s_add_u32 s15, s15, 131072
  v_mfma_f32_16x16x32_bf16 v[64:67], v[104:107], v[200:203], 0
  s_mov_b32 m0, s14
  s_nop 0
  s_add_u32 s14, s14, 4096
  v_mfma_f32_16x16x32_bf16 v[68:71], v[200:203], v[200:203], 0
  buffer_load_dwordx4 v10, s[44:47], s15 offen sc1 lds
  s_add_u32 s15, s15, 131072
  s_waitcnt lgkmcnt(0)
  s_waitcnt vmcnt(9)
  s_barrier
  s_nop 0
  v_mfma_f32_16x16x32_bf16 v[16:19], v[88:91], a[68:71], v[16:19]
  ds_read_b64_tr_b16 v[72:73], v4 offset:8192
  ds_read_b64_tr_b16 v[74:75], v4 offset:8704
  v_mfma_f32_16x16x32_bf16 v[32:35], v[88:91], a[132:135], v[32:35]
  ds_read_b64_tr_b16 v[76:77], v5 offset:8192
  ds_read_b64_tr_b16 v[78:79], v5 offset:8704
  v_mfma_f32_16x16x32_bf16 v[20:23], v[92:95], a[68:71], v[20:23]
  ds_read_b64_tr_b16 v[80:81], v6 offset:8192
  ds_read_b64_tr_b16 v[82:83], v6 offset:8704
  v_mfma_f32_16x16x32_bf16 v[36:39], v[92:95], a[132:135], v[36:39]
  ds_read_b64_tr_b16 v[84:85], v7 offset:8192
  ds_read_b64_tr_b16 v[86:87], v7 offset:8704
  v_mfma_f32_16x16x32_bf16 v[24:27], v[96:99], a[68:71], v[24:27]
  ds_read_b64_tr_b16 v[200:201], v4 offset:12288
  ds_read_b64_tr_b16 v[202:203], v4 offset:12800
  v_mfma_f32_16x16x32_bf16 v[40:43], v[96:99], a[132:135], v[40:43]
  ds_read_b64_tr_b16 v[204:205], v4 offset:16384
  ds_read_b64_tr_b16 v[206:207], v4 offset:16896
  v_mfma_f32_16x16x32_bf16 v[28:31], v[100:103], a[68:71], v[28:31]
  s_mov_b32 m0, s14
  s_nop 0
  s_add_u32 s14, s14, 4096
  v_mfma_f32_16x16x32_bf16 v[44:47], v[100:103], a[132:135], v[44:47]
  buffer_load_dwordx4 v10, s[44:47], s15 offen sc1 lds
  s_add_u32 s15, s15, 131072
  v_mfma_f32_16x16x32_bf16 v[64:67], v[104:107], v[208:211], v[64:67]
  s_mov_b32 m0, s14
  s_add_u32 s14, s14, 4096
  v_mfma_f32_16x16x32_bf16 v[68:71], v[208:211], v[208:211], v[68:71]
  buffer_load_dwordx4 v10, s[44:47], s15 offen sc1 lds
  s_add_u32 s15, s15, 131072
  v_mfma_f32_16x16x32_bf16 v[64:67], v[104:107], v[212:215], v[64:67]
  v_mfma_f32_16x16x32_bf16 v[68:71], v[212:215], v[212:215], v[68:71]
  s_waitcnt lgkmcnt(0)
  s_waitcnt vmcnt(7)
  s_barrier
  v_mfma_f32_16x16x32_bf16 v[16:19], v[72:75], a[72:75], v[16:19]
  ds_read_b64_tr_b16 v[88:89], v4 offset:12288
  ds_read_b64_tr_b16 v[90:91], v4 offset:12800
  v_mfma_f32_16x16x32_bf16 v[32:35], v[72:75], a[136:139], v[32:35]
  ds_read_b64_tr_b16 v[92:93], v5 offset:12288
  ds_read_b64_tr_b16 v[94:95], v5 offset:12800
  v_mfma_f32_16x16x32_bf16 v[20:23], v[76:79], a[72:75], v[20:23]
  ds_read_b64_tr_b16 v[96:97], v6 offset:12288
  ds_read_b64_tr_b16 v[98:99], v6 offset:12800
  v_mfma_f32_16x16x32_bf16 v[36:39], v[76:79], a[136:139], v[36:39]
  ds_read_b64_tr_b16 v[100:101], v7 offset:12288
  ds_read_b64_tr_b16 v[102:103], v7 offset:12800
  v_mfma_f32_16x16x32_bf16 v[24:27], v[80:83], a[72:75], v[24:27]
  ds_read_b64_tr_b16 v[208:209], v4 offset:20480
  ds_read_b64_tr_b16 v[210:211], v4 offset:20992
  v_mfma_f32_16x16x32_bf16 v[40:43], v[80:83], a[136:139], v[40:43]
  ds_read_b64_tr_b16 v[212:213], v4 offset:24576
  ds_read_b64_tr_b16 v[214:215], v4 offset:25088
  v_mfma_f32_16x16x32_bf16 v[28:31], v[84:87], a[72:75], v[28:31]
  v_mfma_f32_16x16x32_bf16 v[44:47], v[84:87], a[136:139], v[44:47]
  v_mfma_f32_16x16x32_bf16 v[64:67], v[104:107], v[200:203], v[64:67]
  v_mfma_f32_16x16x32_bf16 v[68:71], v[200:203], v[200:203], v[68:71]
  v_mfma_f32_16x16x32_bf16 v[64:67], v[104:107], v[204:207], v[64:67]
  v_mfma_f32_16x16x32_bf16 v[68:71], v[204:207], v[204:207], v[68:71]
  s_waitcnt lgkmcnt(0)
  v_mfma_f32_16x16x32_bf16 v[16:19], v[88:91], a[76:79], v[16:19]
  ds_read_b64_tr_b16 v[72:73], v4 offset:16384
  ds_read_b64_tr_b16 v[74:75], v4 offset:16896
  v_mfma_f32_16x16x32_bf16 v[32:35], v[88:91], a[140:143], v[32:35]
  ds_read_b64_tr_b16 v[76:77], v5 offset:16384
  ds_read_b64_tr_b16 v[78:79], v5 offset:16896
  v_mfma_f32_16x16x32_bf16 v[20:23], v[92:95], a[76:79], v[20:23]
  ds_read_b64_tr_b16 v[80:81], v6 offset:16384
  ds_read_b64_tr_b16 v[82:83], v6 offset:16896
  v_mfma_f32_16x16x32_bf16 v[36:39], v[92:95], a[140:143], v[36:39]
  ds_read_b64_tr_b16 v[84:85], v7 offset:16384
  ds_read_b64_tr_b16 v[86:87], v7 offset:16896
  v_mfma_f32_16x16x32_bf16 v[24:27], v[96:99], a[76:79], v[24:27]
  ds_read_b64_tr_b16 v[200:201], v4 offset:28672
  ds_read_b64_tr_b16 v[202:203], v4 offset:29184
  v_mfma_f32_16x16x32_bf16 v[40:43], v[96:99], a[140:143], v[40:43]
  ds_read_b64_tr_b16 v[204:205], v4 offset:32768
  ds_read_b64_tr_b16 v[206:207], v4 offset:33280
  v_mfma_f32_16x16x32_bf16 v[28:31], v[100:103], a[76:79], v[28:31]
  v_mfma_f32_16x16x32_bf16 v[44:47], v[100:103], a[140:143], v[44:47]
  v_mfma_f32_16x16x32_bf16 v[64:67], v[104:107], v[208:211], v[64:67]
  v_mfma_f32_16x16x32_bf16 v[68:71], v[208:211], v[208:211], v[68:71]
  v_mfma_f32_16x16x32_bf16 v[64:67], v[104:107], v[212:215], v[64:67]
  v_mfma_f32_16x16x32_bf16 v[68:71], v[212:215], v[212:215], v[68:71]
  s_waitcnt lgkmcnt(0)
  s_waitcnt vmcnt(3)
  s_barrier
  v_mfma_f32_16x16x32_bf16 v[16:19], v[72:75], a[80:83], v[16:19]
  ds_read_b64_tr_b16 v[88:89], v4 offset:20480
  ds_read_b64_tr_b16 v[90:91], v4 offset:20992
  v_mfma_f32_16x16x32_bf16 v[32:35], v[72:75], a[144:147], v[32:35]
  ds_read_b64_tr_b16 v[92:93], v5 offset:20480
  ds_read_b64_tr_b16 v[94:95], v5 offset:20992
  v_mfma_f32_16x16x32_bf16 v[48:51], a[16:19], v[72:75], 0
  ds_read_b64_tr_b16 v[96:97], v6 offset:20480
  ds_read_b64_tr_b16 v[98:99], v6 offset:20992
  v_mfma_f32_16x16x32_bf16 v[20:23], v[76:79], a[80:83], v[20:23]
  ds_read_b64_tr_b16 v[100:101], v7 offset:20480
  ds_read_b64_tr_b16 v[102:103], v7 offset:20992
  v_mfma_f32_16x16x32_bf16 v[36:39], v[76:79], a[144:147], v[36:39]
  ds_read_b64_tr_b16 v[208:209], v4 offset:36864
  ds_read_b64_tr_b16 v[210:211], v4 offset:37376
  v_mfma_f32_16x16x32_bf16 v[52:55], a[16:19], v[76:79], 0
  ds_read_b64_tr_b16 v[212:213], v4 offset:40960
  ds_read_b64_tr_b16 v[214:215], v4 offset:41472
  v_mfma_f32_16x16x32_bf16 v[24:27], v[80:83], a[80:83], v[24:27]
  v_mfma_f32_16x16x32_bf16 v[40:43], v[80:83], a[144:147], v[40:43]
  v_mfma_f32_16x16x32_bf16 v[56:59], a[16:19], v[80:83], 0
  v_mfma_f32_16x16x32_bf16 v[28:31], v[84:87], a[80:83], v[28:31]
  v_mfma_f32_16x16x32_bf16 v[44:47], v[84:87], a[144:147], v[44:47]
  v_mfma_f32_16x16x32_bf16 v[60:63], a[16:19], v[84:87], 0
  v_mfma_f32_16x16x32_bf16 v[64:67], v[104:107], v[200:203], v[64:67]
  v_mfma_f32_16x16x32_bf16 v[68:71], v[200:203], v[200:203], v[68:71]
  v_mfma_f32_16x16x32_bf16 v[64:67], v[104:107], v[204:207], v[64:67]
  v_mfma_f32_16x16x32_bf16 v[68:71], v[204:207], v[204:207], v[68:71]
  s_waitcnt lgkmcnt(0)
  v_mfma_f32_16x16x32_bf16 v[16:19], v[88:91], a[84:87], v[16:19]
  ds_read_b64_tr_b16 v[72:73], v4 offset:24576
  ds_read_b64_tr_b16 v[74:75], v4 offset:25088
  v_mfma_f32_16x16x32_bf16 v[32:35], v[88:91], a[148:151], v[32:35]
  ds_read_b64_tr_b16 v[76:77], v5 offset:24576
  ds_read_b64_tr_b16 v[78:79], v5 offset:25088
  v_mfma_f32_16x16x32_bf16 v[48:51], a[20:23], v[88:91], v[48:51]
  ds_read_b64_tr_b16 v[80:81], v6 offset:24576
  ds_read_b64_tr_b16 v[82:83], v6 offset:25088
  v_mfma_f32_16x16x32_bf16 v[20:23], v[92:95], a[84:87], v[20:23]
  ds_read_b64_tr_b16 v[84:85], v7 offset:24576
  ds_read_b64_tr_b16 v[86:87], v7 offset:25088
  v_mfma_f32_16x16x32_bf16 v[36:39], v[92:95], a[148:151], v[36:39]
  ds_read_b64_tr_b16 v[200:201], v4 offset:45056
  ds_read_b64_tr_b16 v[202:203], v4 offset:45568
  v_mfma_f32_16x16x32_bf16 v[52:55], a[20:23], v[92:95], v[52:55]
  ds_read_b64_tr_b16 v[204:205], v4 offset:49152
  ds_read_b64_tr_b16 v[206:207], v4 offset:49664
  v_mfma_f32_16x16x32_bf16 v[24:27], v[96:99], a[84:87], v[24:27]
  v_mfma_f32_16x16x32_bf16 v[40:43], v[96:99], a[148:151], v[40:43]
  v_mfma_f32_16x16x32_bf16 v[56:59], a[20:23], v[96:99], v[56:59]
  v_mfma_f32_16x16x32_bf16 v[28:31], v[100:103], a[84:87], v[28:31]
  v_mfma_f32_16x16x32_bf16 v[44:47], v[100:103], a[148:151], v[44:47]
  v_mfma_f32_16x16x32_bf16 v[60:63], a[20:23], v[100:103], v[60:63]
  v_mfma_f32_16x16x32_bf16 v[64:67], v[104:107], v[208:211], v[64:67]
  v_mfma_f32_16x16x32_bf16 v[68:71], v[208:211], v[208:211], v[68:71]
  v_mfma_f32_16x16x32_bf16 v[64:67], v[104:107], v[212:215], v[64:67]
  v_mfma_f32_16x16x32_bf16 v[68:71], v[212:215], v[212:215], v[68:71]
  s_waitcnt lgkmcnt(0)
  s_waitcnt vmcnt(0)
  s_barrier
  v_mfma_f32_16x16x32_bf16 v[16:19], v[72:75], a[88:91], v[16:19]
  ds_read_b64_tr_b16 v[88:89], v4 offset:28672
  ds_read_b64_tr_b16 v[90:91], v4 offset:29184
  v_mfma_f32_16x16x32_bf16 v[32:35], v[72:75], a[152:155], v[32:35]
  ds_read_b64_tr_b16 v[92:93], v5 offset:28672
  ds_read_b64_tr_b16 v[94:95], v5 offset:29184
  v_mfma_f32_16x16x32_bf16 v[48:51], a[24:27], v[72:75], v[48:51]
  ds_read_b64_tr_b16 v[96:97], v6 offset:28672
  ds_read_b64_tr_b16 v[98:99], v6 offset:29184
  v_mfma_f32_16x16x32_bf16 v[20:23], v[76:79], a[88:91], v[20:23]
  ds_read_b64_tr_b16 v[100:101], v7 offset:28672
  ds_read_b64_tr_b16 v[102:103], v7 offset:29184
  v_mfma_f32_16x16x32_bf16 v[36:39], v[76:79], a[152:155], v[36:39]
  ds_read_b64_tr_b16 v[208:209], v4 offset:53248
  ds_read_b64_tr_b16 v[210:211], v4 offset:53760
  v_mfma_f32_16x16x32_bf16 v[52:55], a[24:27], v[76:79], v[52:55]
  ds_read_b64_tr_b16 v[212:213], v4 offset:57344
  ds_read_b64_tr_b16 v[214:215], v4 offset:57856
  v_mfma_f32_16x16x32_bf16 v[24:27], v[80:83], a[88:91], v[24:27]
  v_mfma_f32_16x16x32_bf16 v[40:43], v[80:83], a[152:155], v[40:43]
  v_mfma_f32_16x16x32_bf16 v[56:59], a[24:27], v[80:83], v[56:59]
  v_mfma_f32_16x16x32_bf16 v[28:31], v[84:87], a[88:91], v[28:31]
  v_mfma_f32_16x16x32_bf16 v[44:47], v[84:87], a[152:155], v[44:47]
  v_mfma_f32_16x16x32_bf16 v[60:63], a[24:27], v[84:87], v[60:63]
  v_mfma_f32_16x16x32_bf16 v[64:67], v[104:107], v[200:203], v[64:67]
  v_mfma_f32_16x16x32_bf16 v[68:71], v[200:203], v[200:203], v[68:71]
  v_mfma_f32_16x16x32_bf16 v[64:67], v[104:107], v[204:207], v[64:67]
  v_mfma_f32_16x16x32_bf16 v[68:71], v[204:207], v[204:207], v[68:71]
  s_cmp_eq_u32 s6, 0
  s_cbranch_scc0 WQG_39
  s_add_u32 s13, s79, 0
  s_nop 0
  buffer_load_dwordx4 a[0:3], v111, s[44:47], s13 offen sc1
  s_add_u32 s13, s79, 1024
  buffer_load_dwordx4 a[4:7], v111, s[44:47], s13 offen sc1
  s_add_u32 s13, s79, 2048
  buffer_load_dwordx4 a[8:11], v111, s[44:47], s13 offen sc1
  s_add_u32 s13, s79, 3072
  buffer_load_dwordx4 a[12:15], v111, s[44:47], s13 offen sc1
WQG_39:
  s_waitcnt lgkmcnt(0)
  v_mfma_f32_16x16x32_bf16 v[16:19], v[88:91], a[92:95], v[16:19]
  ds_read_b64_tr_b16 v[72:73], v4 offset:32768
  ds_read_b64_tr_b16 v[74:75], v4 offset:33280
  v_mfma_f32_16x16x32_bf16 v[32:35], v[88:91], a[156:159], v[32:35]
  ds_read_b64_tr_b16 v[76:77], v5 offset:32768
  ds_read_b64_tr_b16 v[78:79], v5 offset:33280
  v_mfma_f32_16x16x32_bf16 v[48:51], a[28:31], v[88:91], v[48:51]
  ds_read_b64_tr_b16 v[80:81], v6 offset:32768
  ds_read_b64_tr_b16 v[82:83], v6 offset:33280
  v_mfma_f32_16x16x32_bf16 v[20:23], v[92:95], a[92:95], v[20:23]
  ds_read_b64_tr_b16 v[84:85], v7 offset:32768
  ds_read_b64_tr_b16 v[86:87], v7 offset:33280
  v_mfma_f32_16x16x32_bf16 v[36:39], v[92:95], a[156:159], v[36:39]
  ds_read_b64_tr_b16 v[200:201], v4 offset:61440
  ds_read_b64_tr_b16 v[202:203], v4 offset:61952
  v_mfma_f32_16x16x32_bf16 v[52:55], a[28:31], v[92:95], v[52:55]
  v_mfma_f32_16x16x32_bf16 v[24:27], v[96:99], a[92:95], v[24:27]
  v_mfma_f32_16x16x32_bf16 v[40:43], v[96:99], a[156:159], v[40:43]
  v_mfma_f32_16x16x32_bf16 v[56:59], a[28:31], v[96:99], v[56:59]
  v_mfma_f32_16x16x32_bf16 v[28:31], v[100:103], a[92:95], v[28:31]
  v_mfma_f32_16x16x32_bf16 v[44:47], v[100:103], a[156:159], v[44:47]
  v_mfma_f32_16x16x32_bf16 v[60:63], a[28:31], v[100:103], v[60:63]
  v_mfma_f32_16x16x32_bf16 v[64:67], v[104:107], v[208:211], v[64:67]
  v_mfma_f32_16x16x32_bf16 v[68:71], v[208:211], v[208:211], v[68:71]
  v_mfma_f32_16x16x32_bf16 v[64:67], v[104:107], v[212:215], v[64:67]
  v_mfma_f32_16x16x32_bf16 v[68:71], v[212:215], v[212:215], v[68:71]
  s_waitcnt lgkmcnt(0)
  v_mfma_f32_16x16x32_bf16 v[16:19], v[72:75], a[96:99], v[16:19]
  ds_read_b64_tr_b16 v[88:89], v4 offset:36864
  ds_read_b64_tr_b16 v[90:91], v4 offset:37376
  v_mfma_f32_16x16x32_bf16 v[32:35], v[72:75], a[160:163], v[32:35]
  ds_read_b64_tr_b16 v[92:93], v5 offset:36864
  ds_read_b64_tr_b16 v[94:95], v5 offset:37376
  v_mfma_f32_16x16x32_bf16 v[48:51], a[32:35], v[72:75], v[48:51]
  ds_read_b64_tr_b16 v[96:97], v6 offset:36864
  ds_read_b64_tr_b16 v[98:99], v6 offset:37376
  v_mfma_f32_16x16x32_bf16 v[20:23], v[76:79], a[96:99], v[20:23]
  ds_read_b64_tr_b16 v[100:101], v7 offset:36864
  ds_read_b64_tr_b16 v[102:103], v7 offset:37376
  v_mfma_f32_16x16x32_bf16 v[36:39], v[76:79], a[160:163], v[36:39]
  v_mfma_f32_16x16x32_bf16 v[52:55], a[32:35], v[76:79], v[52:55]
  v_mfma_f32_16x16x32_bf16 v[24:27], v[80:83], a[96:99], v[24:27]
  v_mfma_f32_16x16x32_bf16 v[40:43], v[80:83], a[160:163], v[40:43]
  v_mfma_f32_16x16x32_bf16 v[56:59], a[32:35], v[80:83], v[56:59]
  v_mfma_f32_16x16x32_bf16 v[28:31], v[84:87], a[96:99], v[28:31]
  v_mfma_f32_16x16x32_bf16 v[44:47], v[84:87], a[160:163], v[44:47]
  v_mfma_f32_16x16x32_bf16 v[60:63], a[32:35], v[84:87], v[60:63]
  v_mfma_f32_16x16x32_bf16 v[64:67], v[104:107], v[200:203], v[64:67]
  v_mfma_f32_16x16x32_bf16 v[68:71], v[200:203], v[200:203], v[68:71]
  s_waitcnt lgkmcnt(0)
  s_nop 0
  v_mfma_f32_16x16x32_bf16 v[16:19], v[88:91], a[100:103], v[16:19]
  ds_read_b64_tr_b16 v[72:73], v4 offset:40960
  ds_read_b64_tr_b16 v[74:75], v4 offset:41472
  v_mfma_f32_16x16x32_bf16 v[32:35], v[88:91], a[164:167], v[32:35]
  ds_read_b64_tr_b16 v[76:77], v5 offset:40960
  ds_read_b64_tr_b16 v[78:79], v5 offset:41472
  v_mfma_f32_16x16x32_bf16 v[48:51], a[36:39], v[88:91], v[48:51]
  ds_read_b64_tr_b16 v[80:81], v6 offset:40960
  ds_read_b64_tr_b16 v[82:83], v6 offset:41472
  v_mfma_f32_16x16x32_bf16 v[20:23], v[92:95], a[100:103], v[20:23]
  ds_read_b64_tr_b16 v[84:85], v7 offset:40960
  ds_read_b64_tr_b16 v[86:87], v7 offset:41472
  v_mfma_f32_16x16x32_bf16 v[36:39], v[92:95], a[164:167], v[36:39]
  v_and_b32 v8, 3, v243
  v_lshrrev_b32 v9, 2, v243
  v_mfma_f32_16x16x32_bf16 v[52:55], a[36:39], v[92:95], v[52:55]
  v_cmp_eq_u32 s[66:67], 1, v8
  v_cmp_eq_u32 s[68:69], 2, v8
  v_mfma_f32_16x16x32_bf16 v[24:27], v[96:99], a[100:103], v[24:27]
  v_cmp_eq_u32 vcc, 3, v8
  v_cndmask_b32 v109, v68, v69, s[66:67]
  v_mfma_f32_16x16x32_bf16 v[40:43], v[96:99], a[164:167], v[40:43]
  v_cndmask_b32 v109, v109, v70, s[68:69]
  v_cndmask_b32 v109, v109, v71, vcc
  v_mfma_f32_16x16x32_bf16 v[56:59], a[36:39], v[96:99], v[56:59]
  v_cmp_eq_u32 vcc, v9, v242
  s_lshl_b32 s8, s3, 6
  v_mfma_f32_16x16x32_bf16 v[28:31], v[100:103], a[100:103], v[28:31]
  s_add_u32 s8, s8, 147968
  v_cndmask_b32 v109, 0, v109, vcc
  v_mfma_f32_16x16x32_bf16 v[44:47], v[100:103], a[164:167], v[44:47]
  v_lshlrev_b32 v8, 2, v243
  v_add_u32_e64 v9, s8, v8
  v_mfma_f32_16x16x32_bf16 v[60:63], a[36:39], v[100:103], v[60:63]
  v_mov_b32 v110, v109
  s_nop 1
  v_permlane16_swap_b32 v109, v110
  s_waitcnt lgkmcnt(0)
  v_mfma_f32_16x16x32_bf16 v[16:19], v[72:75], a[104:107], v[16:19]
  ds_read_b64_tr_b16 v[88:89], v4 offset:45056
  ds_read_b64_tr_b16 v[90:91], v4 offset:45568
  v_mfma_f32_16x16x32_bf16 v[32:35], v[72:75], a[168:171], v[32:35]
  ds_read_b64_tr_b16 v[92:93], v5 offset:45056
  ds_read_b64_tr_b16 v[94:95], v5 offset:45568
  v_mfma_f32_16x16x32_bf16 v[48:51], a[40:43], v[72:75], v[48:51]
  ds_read_b64_tr_b16 v[96:97], v6 offset:45056
  ds_read_b64_tr_b16 v[98:99], v6 offset:45568
  v_mfma_f32_16x16x32_bf16 v[20:23], v[76:79], a[104:107], v[20:23]
  ds_read_b64_tr_b16 v[100:101], v7 offset:45056
  ds_read_b64_tr_b16 v[102:103], v7 offset:45568
  v_mfma_f32_16x16x32_bf16 v[36:39], v[76:79], a[168:171], v[36:39]
  v_add_f32 v109, v109, v110
  v_mov_b32 v110, v109
  v_mfma_f32_16x16x32_bf16 v[52:55], a[40:43], v[76:79], v[52:55]
  s_nop 0
  v_permlane32_swap_b32 v109, v110
  v_add_f32_e64 v109, v109, v110
  v_mfma_f32_16x16x32_bf16 v[24:27], v[80:83], a[104:107], v[24:27]
  v_mul_f32 v118, 0x3b000000, v64
  v_mul_f32 v119, 0x3b000000, v109
  v_mfma_f32_16x16x32_bf16 v[40:43], v[80:83], a[168:171], v[40:43]
  v_fma_f32 v119, -v118, v118, v119
  v_cvt_pk_bf16_f32 v120, v118, v119
  v_mfma_f32_16x16x32_bf16 v[56:59], a[40:43], v[80:83], v[56:59]
  v_lshlrev_b32_e64 v118, 16, v120
  v_and_b32 v119, 0xffff0000, v120
  v_mfma_f32_16x16x32_bf16 v[28:31], v[84:87], a[104:107], v[28:31]
  v_add_f32 v119, 0x3727c5ac, v119
  v_cvt_pk_bf16_f32 v119, v119, v119
  v_mfma_f32_16x16x32_bf16 v[44:47], v[84:87], a[168:171], v[44:47]
  v_and_b32 v119, 0xffff0000, v119
  v_sqrt_f32_e64 v119, v119
  v_mfma_f32_16x16x32_bf16 v[60:63], a[40:43], v[84:87], v[60:63]
  v_cvt_pk_bf16_f32 v119, v119, v119
  v_and_b32 v119, 0xffff0000, v119
  s_waitcnt lgkmcnt(0)
  s_nop 0
  v_mfma_f32_16x16x32_bf16 v[16:19], v[88:91], a[108:111], v[16:19]
  ds_read_b64_tr_b16 v[72:73], v4 offset:49152
  ds_read_b64_tr_b16 v[74:75], v4 offset:49664
  v_mfma_f32_16x16x32_bf16 v[32:35], v[88:91], a[172:175], v[32:35]
  ds_read_b64_tr_b16 v[76:77], v5 offset:49152
  ds_read_b64_tr_b16 v[78:79], v5 offset:49664
  v_mfma_f32_16x16x32_bf16 v[48:51], a[44:47], v[88:91], v[48:51]
  ds_read_b64_tr_b16 v[80:81], v6 offset:49152
  ds_read_b64_tr_b16 v[82:83], v6 offset:49664
  v_mfma_f32_16x16x32_bf16 v[20:23], v[92:95], a[108:111], v[20:23]
  ds_read_b64_tr_b16 v[84:85], v7 offset:49152
  ds_read_b64_tr_b16 v[86:87], v7 offset:49664
  v_mfma_f32_16x16x32_bf16 v[36:39], v[92:95], a[172:175], v[36:39]
  v_rcp_f32 v116, v119
  s_nop 0
  v_mul_f32_e64 v117, v118, v116
  v_mfma_f32_16x16x32_bf16 v[52:55], a[44:47], v[92:95], v[52:55]
  ds_write_b32 v9, v116
  ds_write_b32 v9, v117 offset:256
  v_mfma_f32_16x16x32_bf16 v[24:27], v[96:99], a[108:111], v[24:27]
  v_lshlrev_b32 v8, 4, v242
  v_add_u32 v8, s8, v8
  v_mfma_f32_16x16x32_bf16 v[40:43], v[96:99], a[172:175], v[40:43]
  v_mfma_f32_16x16x32_bf16 v[56:59], a[44:47], v[96:99], v[56:59]
  v_mfma_f32_16x16x32_bf16 v[28:31], v[100:103], a[108:111], v[28:31]
  v_mfma_f32_16x16x32_bf16 v[44:47], v[100:103], a[172:175], v[44:47]
  v_mfma_f32_16x16x32_bf16 v[60:63], a[44:47], v[100:103], v[60:63]
  s_waitcnt lgkmcnt(0)
  s_barrier
  s_waitcnt lgkmcnt(0)
  s_nop 0
  v_mfma_f32_16x16x32_bf16 v[16:19], v[72:75], a[112:115], v[16:19]
  ds_read_b64_tr_b16 v[88:89], v4 offset:53248
  ds_read_b64_tr_b16 v[90:91], v4 offset:53760
  v_mfma_f32_16x16x32_bf16 v[32:35], v[72:75], a[176:179], v[32:35]
  ds_read_b64_tr_b16 v[92:93], v5 offset:53248
  ds_read_b64_tr_b16 v[94:95], v5 offset:53760
  v_mfma_f32_16x16x32_bf16 v[48:51], a[48:51], v[72:75], v[48:51]
  ds_read_b64_tr_b16 v[96:97], v6 offset:53248
  ds_read_b64_tr_b16 v[98:99], v6 offset:53760
  v_mfma_f32_16x16x32_bf16 v[20:23], v[76:79], a[112:115], v[20:23]
  ds_read_b64_tr_b16 v[100:101], v7 offset:53248
  ds_read_b64_tr_b16 v[102:103], v7 offset:53760
  v_mfma_f32_16x16x32_bf16 v[36:39], v[76:79], a[176:179], v[36:39]
  v_xor_b32 v120, 0, v8
  v_xor_b32 v124, 0, v9
  v_mfma_f32_16x16x32_bf16 v[52:55], a[48:51], v[76:79], v[52:55]
  v_xor_b32 v121, 64, v8
  v_xor_b32 v125, 64, v9
  v_mfma_f32_16x16x32_bf16 v[24:27], v[80:83], a[112:115], v[24:27]
  v_xor_b32 v122, 128, v8
  v_xor_b32 v126, 128, v9
  v_mfma_f32_16x16x32_bf16 v[40:43], v[80:83], a[176:179], v[40:43]
  v_xor_b32 v123, 192, v8
  v_xor_b32 v127, 192, v9
  v_mfma_f32_16x16x32_bf16 v[56:59], a[48:51], v[80:83], v[56:59]
  ds_read_b128 v[128:131], v120
  ds_read_b128 v[144:147], v120 offset:256
  v_mfma_f32_16x16x32_bf16 v[28:31], v[84:87], a[112:115], v[28:31]
  ds_read_b128 v[132:135], v121
  ds_read_b128 v[148:151], v121 offset:256
  v_mfma_f32_16x16x32_bf16 v[44:47], v[84:87], a[176:179], v[44:47]
  ds_read_b128 v[136:139], v122
  ds_read_b128 v[152:155], v122 offset:256
  v_mfma_f32_16x16x32_bf16 v[60:63], a[48:51], v[84:87], v[60:63]
  ds_read_b128 v[140:143], v123
  ds_read_b128 v[156:159], v123 offset:256
  s_cmp_eq_u32 s6, 0
  s_cbranch_scc0 WOG_40
  s_mov_b32 m0, s85
  s_add_u32 s85, s85, 1024
  buffer_load_dwordx4 v111, s[44:47], s84 offen sc1 lds
  s_add_u32 s84, s84, 1024
  s_mov_b32 m0, s85
  s_add_u32 s85, s85, 1024
  buffer_load_dwordx4 v111, s[44:47], s84 offen sc1 lds
  s_add_u32 s84, s84, 1024
  s_mov_b32 m0, s85
  s_add_u32 s85, s85, 1024
  buffer_load_dwordx4 v111, s[44:47], s84 offen sc1 lds
  s_add_u32 s84, s84, 1024
  s_mov_b32 m0, s85
  s_add_u32 s85, s85, 1024
  buffer_load_dwordx4 v111, s[44:47], s84 offen sc1 lds
  s_add_u32 s84, s84, 1024
WOG_40:
  s_waitcnt lgkmcnt(0)
  s_nop 0
  v_mfma_f32_16x16x32_bf16 v[16:19], v[88:91], a[116:119], v[16:19]
  ds_read_b64_tr_b16 v[72:73], v4 offset:57344
  ds_read_b64_tr_b16 v[74:75], v4 offset:57856
  v_mfma_f32_16x16x32_bf16 v[32:35], v[88:91], a[180:183], v[32:35]
  ds_read_b64_tr_b16 v[76:77], v5 offset:57344
  ds_read_b64_tr_b16 v[78:79], v5 offset:57856
  v_mfma_f32_16x16x32_bf16 v[48:51], a[52:55], v[88:91], v[48:51]
  ds_read_b64_tr_b16 v[80:81], v6 offset:57344
  ds_read_b64_tr_b16 v[82:83], v6 offset:57856
  v_mfma_f32_16x16x32_bf16 v[20:23], v[92:95], a[116:119], v[20:23]
  ds_read_b64_tr_b16 v[84:85], v7 offset:57344
  ds_read_b64_tr_b16 v[86:87], v7 offset:57856
  v_mfma_f32_16x16x32_bf16 v[36:39], v[92:95], a[180:183], v[36:39]
  ds_read_b32 v160, v124
  ds_read_b32 v208, v124 offset:256
  v_mfma_f32_16x16x32_bf16 v[52:55], a[52:55], v[92:95], v[52:55]
  ds_read_b32 v162, v125
  ds_read_b32 v210, v125 offset:256
  v_mfma_f32_16x16x32_bf16 v[24:27], v[96:99], a[116:119], v[24:27]
  ds_read_b32 v164, v126
  ds_read_b32 v212, v126 offset:256
  v_mfma_f32_16x16x32_bf16 v[40:43], v[96:99], a[180:183], v[40:43]
  ds_read_b32 v166, v127
  ds_read_b32 v214, v127 offset:256
  v_mfma_f32_16x16x32_bf16 v[56:59], a[52:55], v[96:99], v[56:59]
  s_lshl_b32 s8, s5, 2
  s_add_u32 s8, s8, s3
  v_mfma_f32_16x16x32_bf16 v[28:31], v[100:103], a[116:119], v[28:31]
  s_lshl_b32 s9, s8, 10
  s_add_u32 s9, s9, s76
  v_mfma_f32_16x16x32_bf16 v[44:47], v[100:103], a[180:183], v[44:47]
  v_lshlrev_b32 v11, 2, v255
  v_add_u32 v14, s9, v11
  v_mfma_f32_16x16x32_bf16 v[60:63], a[52:55], v[100:103], v[60:63]
  s_lshl_b32 s9, s8, 10
  s_add_u32 s9, s9, s77
  s_waitcnt lgkmcnt(0)
  s_nop 0
  v_mfma_f32_16x16x32_bf16 v[16:19], v[72:75], a[120:123], v[16:19]
  ds_read_b64_tr_b16 v[88:89], v4 offset:61440
  ds_read_b64_tr_b16 v[90:91], v4 offset:61952
  v_mfma_f32_16x16x32_bf16 v[32:35], v[72:75], a[184:187], v[32:35]
  ds_read_b64_tr_b16 v[92:93], v5 offset:61440
  ds_read_b64_tr_b16 v[94:95], v5 offset:61952
  v_mfma_f32_16x16x32_bf16 v[48:51], a[56:59], v[72:75], v[48:51]
  ds_read_b64_tr_b16 v[96:97], v6 offset:61440
  ds_read_b64_tr_b16 v[98:99], v6 offset:61952
  v_mfma_f32_16x16x32_bf16 v[20:23], v[76:79], a[120:123], v[20:23]
  ds_read_b64_tr_b16 v[100:101], v7 offset:61440
  ds_read_b64_tr_b16 v[102:103], v7 offset:61952
  v_mfma_f32_16x16x32_bf16 v[36:39], v[76:79], a[184:187], v[36:39]
  s_and_b32 s10, s4, 3
  s_lshl_b32 s10, s10, 8
  v_mfma_f32_16x16x32_bf16 v[52:55], a[56:59], v[76:79], v[52:55]
  s_add_u32 s9, s9, s10
  v_add_u32 v15, s9, v11
  v_mfma_f32_16x16x32_bf16 v[24:27], v[80:83], a[120:123], v[24:27]
  s_lshl_b32 s9, s4, 16
  s_add_u32 s9, s9, s75
  v_mfma_f32_16x16x32_bf16 v[40:43], v[80:83], a[184:187], v[40:43]
  s_lshl_b32 s10, s8, 10
  s_add_u32 s9, s9, s10
  v_mfma_f32_16x16x32_bf16 v[56:59], a[56:59], v[80:83], v[56:59]
  s_and_b32 s10, s3, 1
  s_lshl_b32 s10, s10, 4
  v_mfma_f32_16x16x32_bf16 v[28:31], v[84:87], a[120:123], v[28:31]
  v_xor_b32 v11, s10, v255
  v_lshlrev_b32 v11, 4, v11
  v_mfma_f32_16x16x32_bf16 v[44:47], v[84:87], a[184:187], v[44:47]
  v_add_u32 v11, s9, v11
  s_lshr_b32 s10, s3, 1
  v_mfma_f32_16x16x32_bf16 v[60:63], a[56:59], v[84:87], v[60:63]
  s_lshl_b32 s10, s10, 15
  v_add_u32_e64 v12, s10, v11
  s_waitcnt lgkmcnt(0)
  v_mfma_f32_16x16x32_bf16 v[16:19], v[88:91], a[124:127], v[16:19]
  ds_read_b64_tr_b16 v[72:73], v4 offset:0
  ds_read_b64_tr_b16 v[74:75], v4 offset:512
  v_mfma_f32_16x16x32_bf16 v[32:35], v[88:91], a[188:191], v[32:35]
  ds_read_b64_tr_b16 v[76:77], v5 offset:0
  ds_read_b64_tr_b16 v[78:79], v5 offset:512
  v_mfma_f32_16x16x32_bf16 v[48:51], a[60:63], v[88:91], v[48:51]
  ds_read_b64_tr_b16 v[80:81], v6 offset:0
  ds_read_b64_tr_b16 v[82:83], v6 offset:512
  v_mfma_f32_16x16x32_bf16 v[20:23], v[92:95], a[124:127], v[20:23]
  ds_read_b64_tr_b16 v[84:85], v7 offset:0
  ds_read_b64_tr_b16 v[86:87], v7 offset:512
  v_mfma_f32_16x16x32_bf16 v[36:39], v[92:95], a[188:191], v[36:39]
  s_xor_b32 s10, s10, 0x8000
  v_add_u32_e64 v13, s10, v11
  v_mfma_f32_16x16x32_bf16 v[52:55], a[60:63], v[92:95], v[52:55]
  v_mfma_f32_16x16x32_bf16 v[24:27], v[96:99], a[124:127], v[24:27]
  v_mfma_f32_16x16x32_bf16 v[40:43], v[96:99], a[188:191], v[40:43]
  v_mfma_f32_16x16x32_bf16 v[56:59], a[60:63], v[96:99], v[56:59]
  v_mfma_f32_16x16x32_bf16 v[28:31], v[100:103], a[124:127], v[28:31]
  v_mfma_f32_16x16x32_bf16 v[44:47], v[100:103], a[188:191], v[44:47]
  v_mfma_f32_16x16x32_bf16 v[60:63], a[60:63], v[100:103], v[60:63]
  s_cmp_eq_u32 s6, 0
  s_cbranch_scc0 WOG_41
  s_mov_b32 m0, s85
  s_add_u32 s85, s85, 1024
  buffer_load_dwordx4 v111, s[44:47], s84 offen sc1 lds
  s_add_u32 s84, s84, 1024
  s_mov_b32 m0, s85
  s_add_u32 s85, s85, 1024
  buffer_load_dwordx4 v111, s[44:47], s84 offen sc1 lds
  s_add_u32 s84, s84, 1024
  s_mov_b32 m0, s85
  s_add_u32 s85, s85, 1024
  buffer_load_dwordx4 v111, s[44:47], s84 offen sc1 lds
  s_add_u32 s84, s84, 1024
  s_mov_b32 m0, s85
  s_add_u32 s85, s85, 1024
  buffer_load_dwordx4 v111, s[44:47], s84 offen sc1 lds
  s_add_u32 s84, s84, 1024
WOG_41:
  s_waitcnt lgkmcnt(0)
  s_nop 0
  v_pk_fma_f32 v[184:185], v[144:145], v[254:255], v[112:113] op_sel_hi:[1,0,1] neg_lo:[0,0,1] neg_hi:[0,0,1]
  v_pk_fma_f32 v[190:191], v[146:147], v[254:255], v[112:113] op_sel_hi:[1,0,1] neg_lo:[0,0,1] neg_hi:[0,0,1]
  v_pk_fma_f32 v[220:221], v[148:149], v[254:255], v[112:113] op_sel_hi:[1,0,1] neg_lo:[0,0,1] neg_hi:[0,0,1]
  v_pk_fma_f32 v[226:227], v[150:151], v[254:255], v[112:113] op_sel_hi:[1,0,1] neg_lo:[0,0,1] neg_hi:[0,0,1]
  v_pk_mul_f32 v[188:189], v[144:145], v[252:253] op_sel_hi:[1,0]
  v_pk_mul_f32 v[194:195], v[146:147], v[252:253] op_sel_hi:[1,0]
  v_pk_mul_f32 v[224:225], v[148:149], v[252:253] op_sel_hi:[1,0]
  v_pk_mul_f32 v[230:231], v[150:151], v[252:253] op_sel_hi:[1,0]
  v_pk_fma_f32 v[16:17], v[16:17], v[128:129], v[184:185] neg_lo:[0,0,1] neg_hi:[0,0,1]
  v_pk_fma_f32 v[18:19], v[18:19], v[130:131], v[190:191] neg_lo:[0,0,1] neg_hi:[0,0,1]
  v_pk_fma_f32 v[20:21], v[20:21], v[132:133], v[220:221] neg_lo:[0,0,1] neg_hi:[0,0,1]
  v_pk_fma_f32 v[22:23], v[22:23], v[134:135], v[226:227] neg_lo:[0,0,1] neg_hi:[0,0,1]
  v_pk_fma_f32 v[32:33], v[32:33], v[128:129], v[188:189] neg_lo:[0,0,1] neg_hi:[0,0,1]
  v_pk_fma_f32 v[34:35], v[34:35], v[130:131], v[194:195] neg_lo:[0,0,1] neg_hi:[0,0,1]
  v_pk_fma_f32 v[36:37], v[36:37], v[132:133], v[224:225] neg_lo:[0,0,1] neg_hi:[0,0,1]
  v_pk_fma_f32 v[38:39], v[38:39], v[134:135], v[230:231] neg_lo:[0,0,1] neg_hi:[0,0,1]
  v_pk_mul_f32 v[186:187], v[16:17], v[114:115]
  v_pk_mul_f32 v[192:193], v[18:19], v[114:115]
  v_pk_mul_f32 v[222:223], v[20:21], v[114:115]
  v_pk_mul_f32 v[228:229], v[22:23], v[114:115]
  v_cvt_pk_bf16_f32 v176, v32, v33
  v_cvt_pk_bf16_f32 v177, v34, v35
  v_cvt_pk_bf16_f32 v178, v36, v37
  v_cvt_pk_bf16_f32 v179, v38, v39
  v_exp_f32_e64 v186, v186 clamp
  v_exp_f32_e64 v192, v192 clamp
  v_exp_f32_e64 v222, v222 clamp
  v_exp_f32_e64 v228, v228 clamp
  v_exp_f32_e64 v187, v187 clamp
  v_exp_f32_e64 v193, v193 clamp
  v_exp_f32_e64 v223, v223 clamp
  v_exp_f32_e64 v229, v229 clamp
  v_max_f32 v16, v112, v16
  v_max_f32 v18, v112, v18
  v_max_f32 v20, v112, v20
  v_max_f32 v22, v112, v22
  v_max_f32 v17, v112, v17
  v_max_f32 v19, v112, v19
  v_max_f32 v21, v112, v21
  v_max_f32 v23, v112, v23
  v_pk_add_f32 v[16:17], v[16:17], v[186:187]
  v_pk_add_f32 v[18:19], v[18:19], v[192:193]
  v_pk_add_f32 v[20:21], v[20:21], v[222:223]
  v_pk_add_f32 v[22:23], v[22:23], v[228:229]
  v_cvt_pk_bf16_f32 v168, v16, v17
  v_cvt_pk_bf16_f32 v169, v18, v19
  v_cvt_pk_bf16_f32 v170, v20, v21
  v_cvt_pk_bf16_f32 v171, v22, v23
  s_nop 1
  s_nop 0
  v_mfma_f32_16x16x32_bf16 v[196:199], v[176:179], v[168:171], 0
  v_mfma_f32_16x16x32_bf16 v[216:219], v[104:107], v[168:171], 0
  v_pk_fma_f32 v[184:185], v[152:153], v[254:255], v[112:113] op_sel_hi:[1,0,1] neg_lo:[0,0,1] neg_hi:[0,0,1]
  v_pk_fma_f32 v[190:191], v[154:155], v[254:255], v[112:113] op_sel_hi:[1,0,1] neg_lo:[0,0,1] neg_hi:[0,0,1]
  v_pk_fma_f32 v[220:221], v[156:157], v[254:255], v[112:113] op_sel_hi:[1,0,1] neg_lo:[0,0,1] neg_hi:[0,0,1]
  v_pk_fma_f32 v[226:227], v[158:159], v[254:255], v[112:113] op_sel_hi:[1,0,1] neg_lo:[0,0,1] neg_hi:[0,0,1]
  v_pk_mul_f32 v[188:189], v[152:153], v[252:253] op_sel_hi:[1,0]
  v_pk_mul_f32 v[194:195], v[154:155], v[252:253] op_sel_hi:[1,0]
  v_pk_mul_f32 v[224:225], v[156:157], v[252:253] op_sel_hi:[1,0]
  v_pk_mul_f32 v[230:231], v[158:159], v[252:253] op_sel_hi:[1,0]
  v_pk_fma_f32 v[24:25], v[24:25], v[136:137], v[184:185] neg_lo:[0,0,1] neg_hi:[0,0,1]
  v_pk_fma_f32 v[26:27], v[26:27], v[138:139], v[190:191] neg_lo:[0,0,1] neg_hi:[0,0,1]
  v_pk_fma_f32 v[28:29], v[28:29], v[140:141], v[220:221] neg_lo:[0,0,1] neg_hi:[0,0,1]
  v_pk_fma_f32 v[30:31], v[30:31], v[142:143], v[226:227] neg_lo:[0,0,1] neg_hi:[0,0,1]
  v_pk_fma_f32 v[40:41], v[40:41], v[136:137], v[188:189] neg_lo:[0,0,1] neg_hi:[0,0,1]
  v_pk_fma_f32 v[42:43], v[42:43], v[138:139], v[194:195] neg_lo:[0,0,1] neg_hi:[0,0,1]
  v_pk_fma_f32 v[44:45], v[44:45], v[140:141], v[224:225] neg_lo:[0,0,1] neg_hi:[0,0,1]
  v_pk_fma_f32 v[46:47], v[46:47], v[142:143], v[230:231] neg_lo:[0,0,1] neg_hi:[0,0,1]
  v_pk_mul_f32 v[186:187], v[24:25], v[114:115]
  v_pk_mul_f32 v[192:193], v[26:27], v[114:115]
  v_pk_mul_f32 v[222:223], v[28:29], v[114:115]
  v_pk_mul_f32 v[228:229], v[30:31], v[114:115]
  v_cvt_pk_bf16_f32 v180, v40, v41
  v_cvt_pk_bf16_f32 v181, v42, v43
  v_cvt_pk_bf16_f32 v182, v44, v45
  v_cvt_pk_bf16_f32 v183, v46, v47
  v_exp_f32_e64 v186, v186 clamp
  v_exp_f32_e64 v192, v192 clamp
  v_exp_f32_e64 v222, v222 clamp
  v_exp_f32_e64 v228, v228 clamp
  v_exp_f32_e64 v187, v187 clamp
  v_exp_f32_e64 v193, v193 clamp
  v_exp_f32_e64 v223, v223 clamp
  v_exp_f32_e64 v229, v229 clamp
  v_max_f32 v24, v112, v24
  v_max_f32 v26, v112, v26
  v_max_f32 v28, v112, v28
  v_max_f32 v30, v112, v30
  v_max_f32 v25, v112, v25
  v_max_f32 v27, v112, v27
  v_max_f32 v29, v112, v29
  v_max_f32 v31, v112, v31
  v_pk_add_f32 v[24:25], v[24:25], v[186:187]
  v_pk_add_f32 v[26:27], v[26:27], v[192:193]
  v_pk_add_f32 v[28:29], v[28:29], v[222:223]
  v_pk_add_f32 v[30:31], v[30:31], v[228:229]
  v_cvt_pk_bf16_f32 v172, v24, v25
  v_cvt_pk_bf16_f32 v173, v26, v27
  v_cvt_pk_bf16_f32 v174, v28, v29
  v_cvt_pk_bf16_f32 v175, v30, v31
  s_nop 1
  v_mfma_f32_16x16x32_bf16 v[196:199], v[180:183], v[172:175], v[196:199]
  v_mfma_f32_16x16x32_bf16 v[216:219], v[104:107], v[172:175], v[216:219]
  s_nop 6
  buffer_atomic_add_f32 v196, v14, s[44:47], 0 offen offset:0
  buffer_atomic_add_f32 v197, v14, s[44:47], 0 offen offset:256
  buffer_atomic_add_f32 v198, v14, s[44:47], 0 offen offset:512
  buffer_atomic_add_f32 v199, v14, s[44:47], 0 offen offset:768
  s_mov_b64 exec, 0xffff
  buffer_atomic_add_f32 v216, v15, s[44:47], 0 offen
  s_mov_b64 exec, -1
  s_cmp_eq_u32 s6, 0
  s_cbranch_scc0 WOG_42
  s_mov_b32 m0, s85
  s_add_u32 s85, s85, 1024
  buffer_load_dwordx4 v111, s[44:47], s84 offen sc1 lds
  s_add_u32 s84, s84, 1024
  s_mov_b32 m0, s85
  s_add_u32 s85, s85, 1024
  buffer_load_dwordx4 v111, s[44:47], s84 offen sc1 lds
  s_add_u32 s84, s84, 1024
  s_mov_b32 m0, s85
  s_add_u32 s85, s85, 1024
  buffer_load_dwordx4 v111, s[44:47], s84 offen sc1 lds
  s_add_u32 s84, s84, 1024
  s_mov_b32 m0, s85
  s_add_u32 s85, s85, 1024
  buffer_load_dwordx4 v111, s[44:47], s84 offen sc1 lds
  s_add_u32 s84, s84, 1024
WOG_42:
  s_waitcnt vmcnt(17)
  s_waitcnt lgkmcnt(0)
  s_nop 0
  v_mfma_f32_16x16x32_bf16 v[48:51], a[0:3], v[72:75], v[48:51]
  ds_read_b64_tr_b16 v[88:89], v4 offset:4096
  ds_read_b64_tr_b16 v[90:91], v4 offset:4608
  ds_read_b64_tr_b16 v[92:93], v5 offset:4096
  ds_read_b64_tr_b16 v[94:95], v5 offset:4608
  v_mfma_f32_16x16x32_bf16 v[52:55], a[0:3], v[76:79], v[52:55]
  ds_read_b64_tr_b16 v[96:97], v6 offset:4096
  ds_read_b64_tr_b16 v[98:99], v6 offset:4608
  ds_read_b64_tr_b16 v[100:101], v7 offset:4096
  ds_read_b64_tr_b16 v[102:103], v7 offset:4608
  v_mfma_f32_16x16x32_bf16 v[56:59], a[0:3], v[80:83], v[56:59]
  v_mfma_f32_16x16x32_bf16 v[60:63], a[0:3], v[84:87], v[60:63]
  s_waitcnt lgkmcnt(0)
  s_nop 0
  v_mfma_f32_16x16x32_bf16 v[48:51], a[4:7], v[88:91], v[48:51]
  ds_read_b64_tr_b16 v[72:73], v4 offset:8192
  ds_read_b64_tr_b16 v[74:75], v4 offset:8704
  ds_read_b64_tr_b16 v[76:77], v5 offset:8192
  ds_read_b64_tr_b16 v[78:79], v5 offset:8704
  v_mfma_f32_16x16x32_bf16 v[52:55], a[4:7], v[92:95], v[52:55]
  ds_read_b64_tr_b16 v[80:81], v6 offset:8192
  ds_read_b64_tr_b16 v[82:83], v6 offset:8704
  ds_read_b64_tr_b16 v[84:85], v7 offset:8192
  ds_read_b64_tr_b16 v[86:87], v7 offset:8704
  v_mfma_f32_16x16x32_bf16 v[56:59], a[4:7], v[96:99], v[56:59]
  v_mfma_f32_16x16x32_bf16 v[60:63], a[4:7], v[100:103], v[60:63]
  s_cmp_eq_u32 s6, 0
  s_cbranch_scc0 WOG_43
  s_mov_b32 m0, s85
  s_add_u32 s85, s85, 1024
  buffer_load_dwordx4 v111, s[44:47], s84 offen sc1 lds
  s_add_u32 s84, s84, 1024
  s_mov_b32 m0, s85
  s_add_u32 s85, s85, 1024
  buffer_load_dwordx4 v111, s[44:47], s84 offen sc1 lds
  s_add_u32 s84, s84, 1024
  s_mov_b32 m0, s85
  s_add_u32 s85, s85, 1024
  buffer_load_dwordx4 v111, s[44:47], s84 offen sc1 lds
  s_add_u32 s84, s84, 1024
  s_mov_b32 m0, s85
  s_add_u32 s85, s85, 1024
  buffer_load_dwordx4 v111, s[44:47], s84 offen sc1 lds
  s_add_u32 s84, s84, 1024
WOG_43:
  s_waitcnt lgkmcnt(0)
  s_nop 0
  v_mfma_f32_16x16x32_bf16 v[48:51], a[8:11], v[72:75], v[48:51]
  ds_read_b64_tr_b16 v[88:89], v4 offset:12288
  ds_read_b64_tr_b16 v[90:91], v4 offset:12800
  ds_read_b64_tr_b16 v[92:93], v5 offset:12288
  ds_read_b64_tr_b16 v[94:95], v5 offset:12800
  v_mfma_f32_16x16x32_bf16 v[52:55], a[8:11], v[76:79], v[52:55]
  ds_read_b64_tr_b16 v[96:97], v6 offset:12288
  ds_read_b64_tr_b16 v[98:99], v6 offset:12800
  ds_read_b64_tr_b16 v[100:101], v7 offset:12288
  ds_read_b64_tr_b16 v[102:103], v7 offset:12800
  v_mfma_f32_16x16x32_bf16 v[56:59], a[8:11], v[80:83], v[56:59]
  v_mfma_f32_16x16x32_bf16 v[60:63], a[8:11], v[84:87], v[60:63]
  s_waitcnt lgkmcnt(0)
  v_mfma_f32_16x16x32_bf16 v[48:51], a[12:15], v[88:91], v[48:51]
  v_mfma_f32_16x16x32_bf16 v[52:55], a[12:15], v[92:95], v[52:55]
  v_mfma_f32_16x16x32_bf16 v[56:59], a[12:15], v[96:99], v[56:59]
  v_mfma_f32_16x16x32_bf16 v[60:63], a[12:15], v[100:103], v[60:63]
  s_cmp_eq_u32 s6, 0
  s_cbranch_scc0 WSQ_44
  v_mov_b32 v120, s64
  v_mov_b32 v121, s64
  v_mov_b32 v122, s64
  v_mov_b32 v123, s64
  s_nop 1
  v_mfma_f32_16x16x32_bf16 v[124:127], a[0:3], v[120:123], 0
  v_mfma_f32_16x16x32_bf16 v[124:127], a[4:7], v[120:123], v[124:127]
  v_mfma_f32_16x16x32_bf16 v[124:127], a[8:11], v[120:123], v[124:127]
  v_mfma_f32_16x16x32_bf16 v[124:127], a[12:15], v[120:123], v[124:127]
  v_mfma_f32_16x16x32_bf16 v[124:127], a[16:19], v[120:123], v[124:127]
  v_mfma_f32_16x16x32_bf16 v[124:127], a[20:23], v[120:123], v[124:127]
  v_mfma_f32_16x16x32_bf16 v[124:127], a[24:27], v[120:123], v[124:127]
  v_mfma_f32_16x16x32_bf16 v[124:127], a[28:31], v[120:123], v[124:127]
  v_mfma_f32_16x16x32_bf16 v[124:127], a[32:35], v[120:123], v[124:127]
  v_mfma_f32_16x16x32_bf16 v[124:127], a[36:39], v[120:123], v[124:127]
  v_mfma_f32_16x16x32_bf16 v[124:127], a[40:43], v[120:123], v[124:127]
  v_mfma_f32_16x16x32_bf16 v[124:127], a[44:47], v[120:123], v[124:127]
  v_mfma_f32_16x16x32_bf16 v[124:127], a[48:51], v[120:123], v[124:127]
  v_mfma_f32_16x16x32_bf16 v[124:127], a[52:55], v[120:123], v[124:127]
  v_mfma_f32_16x16x32_bf16 v[124:127], a[56:59], v[120:123], v[124:127]
  v_mfma_f32_16x16x32_bf16 v[124:127], a[60:63], v[120:123], v[124:127]
  s_nop 7
  v_mov_b32 v248, v124
  v_mov_b32 v249, v125
  v_mov_b32 v250, v126
  v_mov_b32_e64 v251, v127
WSQ_44:
  v_pk_fma_f32 v[184:185], v[208:209], v[248:249], v[112:113] op_sel_hi:[0,1,1] neg_lo:[0,0,1] neg_hi:[0,0,1]
  v_pk_fma_f32 v[188:189], v[208:209], v[250:251], v[112:113] op_sel_hi:[0,1,1] neg_lo:[0,0,1] neg_hi:[0,0,1]
  v_pk_fma_f32 v[220:221], v[210:211], v[248:249], v[112:113] op_sel_hi:[0,1,1] neg_lo:[0,0,1] neg_hi:[0,0,1]
  v_pk_fma_f32 v[224:225], v[210:211], v[250:251], v[112:113] op_sel_hi:[0,1,1] neg_lo:[0,0,1] neg_hi:[0,0,1]
  v_pk_fma_f32 v[48:49], v[48:49], v[160:161], v[184:185] op_sel_hi:[1,0,1] neg_lo:[0,0,1] neg_hi:[0,0,1]
  v_pk_fma_f32 v[50:51], v[50:51], v[160:161], v[188:189] op_sel_hi:[1,0,1] neg_lo:[0,0,1] neg_hi:[0,0,1]
  v_pk_fma_f32 v[52:53], v[52:53], v[162:163], v[220:221] op_sel_hi:[1,0,1] neg_lo:[0,0,1] neg_hi:[0,0,1]
  v_pk_fma_f32 v[54:55], v[54:55], v[162:163], v[224:225] op_sel_hi:[1,0,1] neg_lo:[0,0,1] neg_hi:[0,0,1]
  v_pk_mul_f32 v[186:187], v[48:49], v[114:115]
  v_pk_mul_f32 v[190:191], v[50:51], v[114:115]
  v_pk_mul_f32 v[222:223], v[52:53], v[114:115]
  v_pk_mul_f32 v[226:227], v[54:55], v[114:115]
  v_exp_f32_e64 v186, v186 clamp
  v_exp_f32_e64 v190, v190 clamp
  v_exp_f32_e64 v222, v222 clamp
  v_exp_f32_e64 v226, v226 clamp
  v_exp_f32_e64 v187, v187 clamp
  v_exp_f32_e64 v191, v191 clamp
  v_exp_f32_e64 v223, v223 clamp
  v_exp_f32_e64 v227, v227 clamp
  v_max_f32 v48, v112, v48
  v_max_f32 v50, v112, v50
  v_max_f32 v52, v112, v52
  v_max_f32 v54, v112, v54
  v_max_f32 v49, v112, v49
  v_max_f32 v51, v112, v51
  v_max_f32 v53, v112, v53
  v_max_f32 v55, v112, v55
  v_pk_add_f32 v[48:49], v[48:49], v[186:187]
  v_pk_add_f32 v[50:51], v[50:51], v[190:191]
  v_pk_add_f32 v[52:53], v[52:53], v[222:223]
  v_pk_add_f32 v[54:55], v[54:55], v[226:227]
  v_cvt_pk_bf16_f32 v200, v48, v49
  v_cvt_pk_bf16_f32 v201, v50, v51
  v_cvt_pk_bf16_f32 v202, v52, v53
  v_cvt_pk_bf16_f32 v203, v54, v55
  s_nop 0
  v_permlane16_swap_b32 v200, v202
  v_permlane16_swap_b32 v201, v203
  s_nop 0
  buffer_store_dwordx4 v[200:203], v12, s[44:47], 0 offen sc1
  v_pk_fma_f32 v[184:185], v[212:213], v[248:249], v[112:113] op_sel_hi:[0,1,1] neg_lo:[0,0,1] neg_hi:[0,0,1]
  v_pk_fma_f32 v[188:189], v[212:213], v[250:251], v[112:113] op_sel_hi:[0,1,1] neg_lo:[0,0,1] neg_hi:[0,0,1]
  v_pk_fma_f32 v[220:221], v[214:215], v[248:249], v[112:113] op_sel_hi:[0,1,1] neg_lo:[0,0,1] neg_hi:[0,0,1]
  v_pk_fma_f32 v[224:225], v[214:215], v[250:251], v[112:113] op_sel_hi:[0,1,1] neg_lo:[0,0,1] neg_hi:[0,0,1]
  v_pk_fma_f32 v[56:57], v[56:57], v[164:165], v[184:185] op_sel_hi:[1,0,1] neg_lo:[0,0,1] neg_hi:[0,0,1]
  v_pk_fma_f32 v[58:59], v[58:59], v[164:165], v[188:189] op_sel_hi:[1,0,1] neg_lo:[0,0,1] neg_hi:[0,0,1]
  v_pk_fma_f32 v[60:61], v[60:61], v[166:167], v[220:221] op_sel_hi:[1,0,1] neg_lo:[0,0,1] neg_hi:[0,0,1]
  v_pk_fma_f32 v[62:63], v[62:63], v[166:167], v[224:225] op_sel_hi:[1,0,1] neg_lo:[0,0,1] neg_hi:[0,0,1]
  v_pk_mul_f32 v[186:187], v[56:57], v[114:115]
  v_pk_mul_f32 v[190:191], v[58:59], v[114:115]
  v_pk_mul_f32 v[222:223], v[60:61], v[114:115]
  v_pk_mul_f32 v[226:227], v[62:63], v[114:115]
  v_exp_f32_e64 v186, v186 clamp
  v_exp_f32_e64 v190, v190 clamp
  v_exp_f32_e64 v222, v222 clamp
  v_exp_f32_e64 v226, v226 clamp
  v_exp_f32_e64 v187, v187 clamp
  v_exp_f32_e64 v191, v191 clamp
  v_exp_f32_e64 v223, v223 clamp
  v_exp_f32_e64 v227, v227 clamp
  v_max_f32 v56, v112, v56
  v_max_f32 v58, v112, v58
  v_max_f32 v60, v112, v60
  v_max_f32 v62, v112, v62
  v_max_f32 v57, v112, v57
  v_max_f32 v59, v112, v59
  v_max_f32 v61, v112, v61
  v_max_f32 v63, v112, v63
  v_pk_add_f32 v[56:57], v[56:57], v[186:187]
  v_pk_add_f32 v[58:59], v[58:59], v[190:191]
  v_pk_add_f32 v[60:61], v[60:61], v[222:223]
  v_pk_add_f32 v[62:63], v[62:63], v[226:227]
  v_cvt_pk_bf16_f32 v204, v56, v57
  v_cvt_pk_bf16_f32 v205, v58, v59
  v_cvt_pk_bf16_f32 v206, v60, v61
  v_cvt_pk_bf16_f32 v207, v62, v63
  s_nop 0
  v_permlane16_swap_b32 v204, v206
  v_permlane16_swap_b32 v205, v207
  buffer_store_dwordx4 v[204:207], v13, s[44:47], 0 offen sc1
  s_waitcnt vmcnt(0) lgkmcnt(0)
  s_barrier
  s_add_u32 s7, s7, 16
  s_cmp_eq_u32 s3, 0
  s_cbranch_scc0 ARR_45
  s_mov_b64 exec, 1
  v_mov_b32 v232, 1
  buffer_atomic_add v232, v239, s[44:47], 0 offen sc0 sc1
  s_mov_b64 exec, -1
ARR_45:
  s_mov_b32 s73, 5242880
  s_lshl_b32 s8, s3, 13
  s_add_u32 s8, s8, s76
  v_lshlrev_b32 v4, 4, v255
  v_add_u32_e64 v4, s8, v4
  v_add_u32 v5, 4096, v4
  s_lshl_b32 s8, s3, 13
  s_add_u32 s8, s8, s77
  v_bfe_u32 v6, v255, 2, 3
  v_lshlrev_b32 v6, 10, v6
  v_lshrrev_b32 v12, 5, v255
  v_lshl_add_u32 v6, v12, 8, v6
  v_and_b32_e64 v12, 3, v255
  v_lshl_add_u32 v6, v12, 4, v6
  v_add_u32 v6, s8, v6
  s_and_b32 s8, s3, 1
  s_lshl_b32 s8, s8, 15
  s_lshr_b32 s9, s3, 1
  s_lshl_b32 s9, s9, 14
  s_add_u32 s8, s8, s9
  s_lshl_b32 s9, s4, 16
  s_add_u32 s8, s8, s9
  s_add_u32 s15, s8, s75
  v_lshlrev_b32 v7, 4, v255
  v_lshrrev_b32 v1, 3, v0
  v_and_b32 v3, 7, v0
  s_lshl_b32 s8, s5, 18
  s_lshl_b32 s9, s4, 7
  s_add_u32 s8, s8, s9
  v_lshlrev_b32 v8, 12, v1
  v_lshl_add_u32 v8, v3, 4, v8
  v_add_u32 v8, s8, v8
  v_add_u32 v9, s72, v8
  v_add_u32 v2, 0x20000, v9
  v_lshrrev_b32_e64 v10, 4, v255
  v_bfe_u32 v11, v255, 2, 2
  v_lshl_add_u32 v10, v11, 2, v10
  v_bfe_u32 v11, v255, 1, 1
  v_lshl_add_u32 v10, v11, 4, v10
  v_lshlrev_b32 v10, 4, v10
  v_and_b32 v11, 1, v255
  v_lshl_add_u32 v10, v11, 3, v10
  s_mul_i32 s8, s3, 4352
  s_add_u32 s8, s8, 82432
  v_add_u32_e64 v10, s8, v10
  v_bfe_u32 v11, v255, 2, 3
  v_mul_u32_u24 v11, 544, v11
  v_and_b32_e64 v12, 3, v255
  v_lshl_add_u32 v11, v12, 3, v11
  v_add_u32 v11, s8, v11
  v_and_b32 v12, 31, v255
  v_lshrrev_b32 v13, 5, v255
  v_lshlrev_b32 v14, 4, v13
  v_add_u32 v15, v14, v12
  v_lshlrev_b32 v15, 4, v15
  v_lshlrev_b32_e64 v14, 4, v13
  v_add_u32 v14, 512, v14
  v_cmp_gt_u32 vcc, 16, v12
  s_nop 1
  v_cndmask_b32 v15, v14, v15, vcc
  s_lshr_b32 s8, s3, 1
  s_mul_i32 s9, s8, 8704
  s_add_u32 s9, s9, 82432
  v_add_u32 v15, s9, v15
  v_lshrrev_b32 v16, 2, v243
  v_lshrrev_b32_e64 v17, 1, v242
  v_lshl_add_u32 v17, v17, 2, v16
  v_lshlrev_b32 v17, 7, v17
  v_and_b32 v18, 3, v243
  v_lshl_add_u32 v17, v18, 3, v17
  s_lshl_b32 s9, s8, 15
  s_add_u32 s9, s9, 0
  v_add_u32 v17, s9, v17
  v_and_b32 v18, 2, v16
  v_and_b32 v19, 1, v242
  v_xor_b32 v18, v18, v19
  v_lshl_add_u32 v13, v18, 5, v17
  v_xor_b32_e64 v18, 2, v18
  v_lshl_add_u32 v14, v18, 5, v17
  s_mul_i32 s9, s8, 17408
  s_and_b32 s8, s3, 1
  s_lshl_b32 s8, s8, 7
  s_add_u32 s9, s9, s8
  s_add_u32 s9, s9, 99840
  v_mul_u32_u24 v16, 272, v12
  v_lshrrev_b32 v17, 5, v255
  v_lshl_add_u32 v16, v17, 4, v16
  v_add_u32_e64 v16, s9, v16
  v_mul_u32_u24 v17, 272, v1
  v_lshl_add_u32 v17, v3, 5, v17
  v_add_u32 v17, 99840, v17
  v_mul_u32_u24 v18, 144, v1
  v_lshl_add_u32 v18, v3, 4, v18
  v_add_u32 v18, 134656, v18
  s_lshr_b32 s8, s3, 1
  s_lshl_b32 s8, s8, 15
  s_add_u32 s8, s8, 0
  v_lshlrev_b32 v13, 4, v255
  v_add_u32_e64 v13, s8, v13
  ds_read_b128 v[104:107], v13 offset:0
  ds_read_b128 v[108:111], v13 offset:1024
  ds_read_b128 v[112:115], v13 offset:2048
  ds_read_b128 v[116:119], v13 offset:3072
  ds_read_b128 v[120:123], v13 offset:4096
  ds_read_b128 v[124:127], v13 offset:5120
  ds_read_b128 v[128:131], v13 offset:6144
  ds_read_b128 v[132:135], v13 offset:7168
  ds_read_b128 v[136:139], v13 offset:8192
  ds_read_b128 v[140:143], v13 offset:9216
  ds_read_b128 v[144:147], v13 offset:10240
  ds_read_b128 v[148:151], v13 offset:11264
  ds_read_b128 v[152:155], v13 offset:12288
  ds_read_b128 v[156:159], v13 offset:13312
  ds_read_b128 v[160:163], v13 offset:14336
  ds_read_b128 v[164:167], v13 offset:15360
  ds_read_b128 v[168:171], v13 offset:16384
  ds_read_b128 v[172:175], v13 offset:17408
  ds_read_b128 v[176:179], v13 offset:18432
  ds_read_b128 v[180:183], v13 offset:19456
  ds_read_b128 v[184:187], v13 offset:20480
  ds_read_b128 v[188:191], v13 offset:21504
  ds_read_b128 v[192:195], v13 offset:22528
  ds_read_b128 v[196:199], v13 offset:23552
  ds_read_b128 v[200:203], v13 offset:24576
  ds_read_b128 v[204:207], v13 offset:25600
  ds_read_b128 v[208:211], v13 offset:26624
  ds_read_b128 v[212:215], v13 offset:27648
  ds_read_b128 v[216:219], v13 offset:28672
  ds_read_b128 v[220:223], v13 offset:29696
  ds_read_b128 v[224:227], v13 offset:30720
  ds_read_b128 v[228:231], v13 offset:31744
  s_cmp_eq_u32 s3, 0
  s_cbranch_scc0 WT_46
  s_mov_b64 exec, 0xffff
  s_mov_b32 s78, 0
  s_cmp_eq_u32 s6, 0
  s_cselect_b32 s9, 2, 1
  s_waitcnt vmcnt(0)
  v_readfirstlane_b32 s8, v232
  s_nop 3
  s_and_b32 s8, s8, 15
  s_sub_u32 s8, 15, s8
  s_mul_i32 s8, s8, s9
  s_add_u32 s8, s8, 0
AD_50:
  s_sleep 1
  s_sub_u32 s8, s8, 1
  s_cmp_gt_i32 s8, 0
  s_cbranch_scc1 AD_50
POLL_47:
  buffer_load_dword v236, v238, s[44:47], 0 offen offset:0 sc1
  s_add_u32 s78, s78, 1
  s_waitcnt vmcnt(0)
  v_cmp_gt_u32 vcc, s7, v236
  s_nop 4
  s_cbranch_vccz PD_48
  s_sleep 4
  s_cmp_lt_u32 s78, 0x200000
  s_cbranch_scc1 POLL_47
PD_48:
  s_mov_b64 exec, -1
WT_46:
  s_barrier
  s_nop 0
  buffer_load_dwordx4 v[24:27], v4, s[44:47], 0 offen offset:0 sc1
  buffer_load_dwordx4 v[28:31], v4, s[44:47], 0 offen offset:1024 sc1
  buffer_load_dwordx4 v[32:35], v4, s[44:47], 0 offen offset:2048 sc1
  buffer_load_dwordx4 v[36:39], v4, s[44:47], 0 offen offset:3072 sc1
  buffer_load_dwordx4 v[40:43], v5, s[44:47], 0 offen offset:0 sc1
  buffer_load_dwordx4 v[44:47], v5, s[44:47], 0 offen offset:1024 sc1
  buffer_load_dwordx4 v[48:51], v5, s[44:47], 0 offen offset:2048 sc1
  buffer_load_dwordx4 v[52:55], v5, s[44:47], 0 offen offset:3072 sc1
  buffer_load_dwordx4 v[56:59], v6, s[44:47], 0 offen sc1
  buffer_load_dwordx4 v[60:63], v6, s[44:47], 0 offen offset:512 sc1
  buffer_load_dwordx4 a[192:195], v7, s[44:47], s15 offen sc1
  s_add_u32 s15, s15, 1024
  buffer_load_dwordx4 a[196:199], v7, s[44:47], s15 offen sc1
  s_add_u32 s15, s15, 1024
  buffer_load_dwordx4 a[200:203], v7, s[44:47], s15 offen sc1
  s_add_u32 s15, s15, 1024
  buffer_load_dwordx4 a[204:207], v7, s[44:47], s15 offen sc1
  s_add_u32 s15, s15, 1024
  s_waitcnt vmcnt(4)
  s_nop 0
  v_cvt_pk_bf16_f32 v24, v24, v25
  v_cvt_pk_bf16_f32 v25, v26, v27
  ds_write_b64 v10, v[24:25] offset:0
  v_cvt_pk_bf16_f32 v28, v28, v29
  v_cvt_pk_bf16_f32 v29, v30, v31
  ds_write_b64 v10, v[28:29] offset:544
  v_cvt_pk_bf16_f32 v32, v32, v33
  v_cvt_pk_bf16_f32 v33, v34, v35
  ds_write_b64 v10, v[32:33] offset:1088
  v_cvt_pk_bf16_f32 v36, v36, v37
  v_cvt_pk_bf16_f32 v37, v38, v39
  ds_write_b64 v10, v[36:37] offset:1632
  v_cvt_pk_bf16_f32 v40, v40, v41
  v_cvt_pk_bf16_f32 v41, v42, v43
  ds_write_b64 v10, v[40:41] offset:2176
  v_cvt_pk_bf16_f32 v44, v44, v45
  v_cvt_pk_bf16_f32 v45, v46, v47
  ds_write_b64 v10, v[44:45] offset:2720
  v_cvt_pk_bf16_f32 v48, v48, v49
  v_cvt_pk_bf16_f32 v49, v50, v51
  ds_write_b64 v10, v[48:49] offset:3264
  v_cvt_pk_bf16_f32 v52, v52, v53
  v_cvt_pk_bf16_f32 v53, v54, v55
  ds_write_b64 v10, v[52:53] offset:3808
  v_pk_add_f32 v[56:57], v[56:57], v[60:61]
  v_pk_add_f32 v[58:59], v[58:59], v[62:63]
  v_mov_b32 v60, v56
  s_nop 1
  v_permlane32_swap_b32 v56, v60
  v_add_f32 v56, v56, v60
  v_mov_b32 v61, v57
  s_nop 1
  v_permlane32_swap_b32 v57, v61
  v_add_f32 v57, v57, v61
  v_mov_b32 v62, v58
  s_nop 1
  v_permlane32_swap_b32 v58, v62
  v_add_f32 v58, v58, v62
  v_mov_b32 v63, v59
  s_nop 1
  v_permlane32_swap_b32 v59, v63
  v_add_f32 v59, v59, v63
  v_cvt_pk_bf16_f32 v56, v56, v57
  v_cvt_pk_bf16_f32 v57, v58, v59
  ds_write_b64 v11, v[56:57] offset:512
  buffer_load_dwordx4 a[208:211], v7, s[44:47], s15 offen sc1
  s_add_u32 s15, s15, 1024
  buffer_load_dwordx4 a[212:215], v7, s[44:47], s15 offen sc1
  s_add_u32 s15, s15, 1024
  buffer_load_dwordx4 a[216:219], v7, s[44:47], s15 offen sc1
  s_add_u32 s15, s15, 1024
  buffer_load_dwordx4 a[220:223], v7, s[44:47], s15 offen sc1
  s_add_u32 s15, s15, 1024
  buffer_load_dwordx4 a[224:227], v7, s[44:47], s15 offen sc1
  s_add_u32 s15, s15, 1024
  buffer_load_dwordx4 a[228:231], v7, s[44:47], s15 offen sc1
  s_add_u32 s15, s15, 1024
  s_waitcnt lgkmcnt(0)
  s_barrier
  ds_read_b128 v[20:23], v15 offset:0
  ds_read_b128 v[24:27], v15 offset:544
  ds_read_b128 v[28:31], v15 offset:1088
  s_waitcnt vmcnt(9) lgkmcnt(2)
  v_mfma_f32_32x32x16_bf16 v[32:47], v[20:23], a[192:195], 0
  s_waitcnt vmcnt(8) lgkmcnt(1)
  v_mfma_f32_32x32x16_bf16 v[48:63], v[24:27], a[196:199], 0
  s_nop 9
  v_add_f32 v40, 0x358637bd, v40
  v_rcp_f32 v40, v40
  s_nop 0
  v_mul_f32 v32, v32, v40
  v_mul_f32 v33, v33, v40
  v_mul_f32 v34, v34, v40
  v_mul_f32 v35, v35, v40
  v_mul_f32 v36, v36, v40
  v_mul_f32 v37, v37, v40
  v_mul_f32 v38, v38, v40
  v_mul_f32_e64 v39, v39, v40
  v_cvt_pk_bf16_f32 v64, v32, v33
  v_cvt_pk_bf16_f32 v65, v34, v35
  v_cvt_pk_bf16_f32 v66, v36, v37
  v_cvt_pk_bf16_f32 v67, v38, v39
  s_waitcnt vmcnt(7) lgkmcnt(0)
  s_nop 0
  v_mfma_f32_32x32x16_bf16 v[72:87], v[64:67], v[104:107], 0
  v_add_f32 v56, 0x358637bd, v56
  v_rcp_f32_e64 v56, v56
  ds_read_b128 v[20:23], v15 offset:1632
  v_mul_f32 v48, v48, v56
  v_mul_f32 v49, v49, v56
  v_mfma_f32_32x32x16_bf16 v[32:47], v[28:31], a[200:203], 0
  v_mul_f32 v50, v50, v56
  v_mul_f32 v51, v51, v56
  v_mul_f32 v52, v52, v56
  v_mul_f32 v53, v53, v56
  v_mul_f32 v54, v54, v56
  v_mul_f32 v55, v55, v56
  v_mfma_f32_32x32x16_bf16 v[88:103], v[64:67], v[108:111], 0
  v_cvt_pk_bf16_f32 v68, v48, v49
  v_cvt_pk_bf16_f32 v69, v50, v51
  v_cvt_pk_bf16_f32 v70, v52, v53
  v_cvt_pk_bf16_f32 v71, v54, v55
  buffer_load_dwordx4 a[232:235], v7, s[44:47], s15 offen sc1
  s_add_u32 s15, s15, 1024
  s_waitcnt vmcnt(7) lgkmcnt(0)
  v_mfma_f32_32x32x16_bf16 v[72:87], v[68:71], v[112:115], v[72:87]
  v_add_f32 v40, 0x358637bd, v40
  v_rcp_f32 v40, v40
  ds_read_b128 v[24:27], v15 offset:2176
  v_mul_f32 v32, v32, v40
  v_mul_f32 v33, v33, v40
  v_mfma_f32_32x32x16_bf16 v[48:63], v[20:23], a[204:207], 0
  v_mul_f32 v34, v34, v40
  v_mul_f32 v35, v35, v40
  v_mul_f32 v36, v36, v40
  v_mul_f32 v37, v37, v40
  v_mul_f32 v38, v38, v40
  v_mul_f32 v39, v39, v40
  v_mfma_f32_32x32x16_bf16 v[88:103], v[68:71], v[116:119], v[88:103]
  v_cvt_pk_bf16_f32 v64, v32, v33
  v_cvt_pk_bf16_f32 v65, v34, v35
  v_cvt_pk_bf16_f32 v66, v36, v37
  v_cvt_pk_bf16_f32 v67, v38, v39
  buffer_load_dwordx4 a[236:239], v7, s[44:47], s15 offen sc1
  s_add_u32 s15, s15, 1024
  s_waitcnt vmcnt(7) lgkmcnt(0)
  v_mfma_f32_32x32x16_bf16 v[72:87], v[64:67], v[120:123], v[72:87]
  v_add_f32 v56, 0x358637bd, v56
  v_rcp_f32 v56, v56
  ds_read_b128 v[28:31], v15 offset:2720
  v_mul_f32 v48, v48, v56
  v_mul_f32 v49, v49, v56
  v_mfma_f32_32x32x16_bf16 v[32:47], v[24:27], a[208:211], 0
  v_mul_f32 v50, v50, v56
  v_mul_f32 v51, v51, v56
  v_mul_f32 v52, v52, v56
  v_mul_f32 v53, v53, v56
  v_mul_f32 v54, v54, v56
  v_mul_f32 v55, v55, v56
  v_mfma_f32_32x32x16_bf16 v[88:103], v[64:67], v[124:127], v[88:103]
  v_cvt_pk_bf16_f32 v68, v48, v49
  v_cvt_pk_bf16_f32 v69, v50, v51
  v_cvt_pk_bf16_f32 v70, v52, v53
  v_cvt_pk_bf16_f32 v71, v54, v55
  buffer_load_dwordx4 a[240:243], v7, s[44:47], s15 offen sc1
  s_add_u32 s15, s15, 1024
  s_waitcnt vmcnt(7) lgkmcnt(0)
  v_mfma_f32_32x32x16_bf16 v[72:87], v[68:71], v[128:131], v[72:87]
  v_add_f32 v40, 0x358637bd, v40
  v_rcp_f32 v40, v40
  ds_read_b128 v[20:23], v15 offset:3264
  v_mul_f32 v32, v32, v40
  v_mul_f32 v33, v33, v40
  v_mfma_f32_32x32x16_bf16 v[48:63], v[28:31], a[212:215], 0
  v_mul_f32 v34, v34, v40
  v_mul_f32 v35, v35, v40
  v_mul_f32 v36, v36, v40
  v_mul_f32 v37, v37, v40
  v_mul_f32 v38, v38, v40
  v_mul_f32 v39, v39, v40
  v_mfma_f32_32x32x16_bf16 v[88:103], v[68:71], v[132:135], v[88:103]
  v_cvt_pk_bf16_f32 v64, v32, v33
  v_cvt_pk_bf16_f32 v65, v34, v35
  v_cvt_pk_bf16_f32 v66, v36, v37
  v_cvt_pk_bf16_f32 v67, v38, v39
  buffer_load_dwordx4 a[244:247], v7, s[44:47], s15 offen sc1
  s_add_u32 s15, s15, 1024
  s_waitcnt vmcnt(7) lgkmcnt(0)
  v_mfma_f32_32x32x16_bf16 v[72:87], v[64:67], v[136:139], v[72:87]
  v_add_f32 v56, 0x358637bd, v56
  v_rcp_f32 v56, v56
  ds_read_b128 v[24:27], v15 offset:3808
  v_mul_f32 v48, v48, v56
  v_mul_f32 v49, v49, v56
  v_mfma_f32_32x32x16_bf16 v[32:47], v[20:23], a[216:219], 0
  v_mul_f32 v50, v50, v56
  v_mul_f32 v51, v51, v56
  v_mul_f32 v52, v52, v56
  v_mul_f32 v53, v53, v56
  v_mul_f32 v54, v54, v56
  v_mul_f32 v55, v55, v56
  v_mfma_f32_32x32x16_bf16 v[88:103], v[64:67], v[140:143], v[88:103]
  v_cvt_pk_bf16_f32 v68, v48, v49
  v_cvt_pk_bf16_f32 v69, v50, v51
  v_cvt_pk_bf16_f32 v70, v52, v53
  v_cvt_pk_bf16_f32 v71, v54, v55
  buffer_load_dwordx4 a[248:251], v7, s[44:47], s15 offen sc1
  s_add_u32 s15, s15, 1024
  s_waitcnt vmcnt(7) lgkmcnt(0)
  v_mfma_f32_32x32x16_bf16 v[72:87], v[68:71], v[144:147], v[72:87]
  v_add_f32 v40, 0x358637bd, v40
  v_rcp_f32 v40, v40
  ds_read_b128 v[28:31], v15 offset:4352
  v_mul_f32 v32, v32, v40
  v_mul_f32 v33, v33, v40
  v_mfma_f32_32x32x16_bf16 v[48:63], v[24:27], a[220:223], 0
  v_mul_f32 v34, v34, v40
  v_mul_f32 v35, v35, v40
  v_mul_f32 v36, v36, v40
  v_mul_f32 v37, v37, v40
  v_mul_f32 v38, v38, v40
  v_mul_f32 v39, v39, v40
  v_mfma_f32_32x32x16_bf16 v[88:103], v[68:71], v[148:151], v[88:103]
  v_cvt_pk_bf16_f32 v64, v32, v33
  v_cvt_pk_bf16_f32 v65, v34, v35
  v_cvt_pk_bf16_f32 v66, v36, v37
  v_cvt_pk_bf16_f32 v67, v38, v39
  buffer_load_dwordx4 a[252:255], v7, s[44:47], s15 offen sc1
  s_add_u32 s15, s15, 1024
  s_waitcnt vmcnt(7) lgkmcnt(0)
  v_mfma_f32_32x32x16_bf16 v[72:87], v[64:67], v[152:155], v[72:87]
  v_add_f32 v56, 0x358637bd, v56
  v_rcp_f32 v56, v56
  ds_read_b128 v[20:23], v15 offset:4896
  v_mul_f32 v48, v48, v56
  v_mul_f32 v49, v49, v56
  v_mfma_f32_32x32x16_bf16 v[32:47], v[28:31], a[224:227], 0
  v_mul_f32 v50, v50, v56
  v_mul_f32 v51, v51, v56
  v_mul_f32 v52, v52, v56
  v_mul_f32 v53, v53, v56
  v_mul_f32 v54, v54, v56
  v_mul_f32 v55, v55, v56
  v_mfma_f32_32x32x16_bf16 v[88:103], v[64:67], v[156:159], v[88:103]
  v_cvt_pk_bf16_f32 v68, v48, v49
  v_cvt_pk_bf16_f32 v69, v50, v51
  v_cvt_pk_bf16_f32 v70, v52, v53
  v_cvt_pk_bf16_f32 v71, v54, v55
  buffer_load_dwordx4 v[104:107], v9, s[44:47], 0 offen sc1
  buffer_load_dwordx4 v[108:111], v2, s[44:47], 0 offen sc1
  s_waitcnt vmcnt(8) lgkmcnt(0)
  v_mfma_f32_32x32x16_bf16 v[72:87], v[68:71], v[160:163], v[72:87]
  v_add_f32 v40, 0x358637bd, v40
  v_rcp_f32 v40, v40
  ds_read_b128 v[24:27], v15 offset:5440
  v_mul_f32 v32, v32, v40
  v_mul_f32 v33, v33, v40
  v_mfma_f32_32x32x16_bf16 v[48:63], v[20:23], a[228:231], 0
  v_mul_f32 v34, v34, v40
  v_mul_f32 v35, v35, v40
  v_mul_f32 v36, v36, v40
  v_mul_f32 v37, v37, v40
  v_mul_f32 v38, v38, v40
  v_mul_f32 v39, v39, v40
  v_mfma_f32_32x32x16_bf16 v[88:103], v[68:71], v[164:167], v[88:103]
  v_cvt_pk_bf16_f32 v64, v32, v33
  v_cvt_pk_bf16_f32 v65, v34, v35
  v_cvt_pk_bf16_f32 v66, v36, v37
  v_cvt_pk_bf16_f32 v67, v38, v39
  s_waitcnt vmcnt(7) lgkmcnt(0)
  s_nop 0
  v_mfma_f32_32x32x16_bf16 v[72:87], v[64:67], v[168:171], v[72:87]
  v_add_f32 v56, 0x358637bd, v56
  v_rcp_f32_e64 v56, v56
  ds_read_b128 v[28:31], v15 offset:5984
  v_mul_f32 v48, v48, v56
  v_mul_f32 v49, v49, v56
  v_mfma_f32_32x32x16_bf16 v[32:47], v[24:27], a[232:235], 0
  v_mul_f32 v50, v50, v56
  v_mul_f32 v51, v51, v56
  v_mul_f32 v52, v52, v56
  v_mul_f32 v53, v53, v56
  v_mul_f32 v54, v54, v56
  v_mul_f32 v55, v55, v56
  v_mfma_f32_32x32x16_bf16 v[88:103], v[64:67], v[172:175], v[88:103]
  v_cvt_pk_bf16_f32 v68, v48, v49
  v_cvt_pk_bf16_f32 v69, v50, v51
  v_cvt_pk_bf16_f32 v70, v52, v53
  v_cvt_pk_bf16_f32 v71, v54, v55
  s_waitcnt vmcnt(6) lgkmcnt(0)
  s_nop 0
  v_mfma_f32_32x32x16_bf16 v[72:87], v[68:71], v[176:179], v[72:87]
  v_add_f32 v40, 0x358637bd, v40
  v_rcp_f32_e64 v40, v40
  ds_read_b128 v[20:23], v15 offset:6528
  v_mul_f32 v32, v32, v40
  v_mul_f32 v33, v33, v40
  v_mfma_f32_32x32x16_bf16 v[48:63], v[28:31], a[236:239], 0
  v_mul_f32 v34, v34, v40
  v_mul_f32 v35, v35, v40
  v_mul_f32 v36, v36, v40
  v_mul_f32 v37, v37, v40
  v_mul_f32 v38, v38, v40
  v_mul_f32 v39, v39, v40
  v_mfma_f32_32x32x16_bf16 v[88:103], v[68:71], v[180:183], v[88:103]
  v_cvt_pk_bf16_f32 v64, v32, v33
  v_cvt_pk_bf16_f32 v65, v34, v35
  v_cvt_pk_bf16_f32 v66, v36, v37
  v_cvt_pk_bf16_f32 v67, v38, v39
  s_waitcnt vmcnt(5) lgkmcnt(0)
  s_nop 0
  v_mfma_f32_32x32x16_bf16 v[72:87], v[64:67], v[184:187], v[72:87]
  v_add_f32 v56, 0x358637bd, v56
  v_rcp_f32_e64 v56, v56
  ds_read_b128 v[24:27], v15 offset:7072
  v_mul_f32 v48, v48, v56
  v_mul_f32 v49, v49, v56
  v_mfma_f32_32x32x16_bf16 v[32:47], v[20:23], a[240:243], 0
  v_mul_f32 v50, v50, v56
  v_mul_f32 v51, v51, v56
  v_mul_f32 v52, v52, v56
  v_mul_f32 v53, v53, v56
  v_mul_f32 v54, v54, v56
  v_mul_f32 v55, v55, v56
  v_mfma_f32_32x32x16_bf16 v[88:103], v[64:67], v[188:191], v[88:103]
  v_cvt_pk_bf16_f32 v68, v48, v49
  v_cvt_pk_bf16_f32 v69, v50, v51
  v_cvt_pk_bf16_f32 v70, v52, v53
  v_cvt_pk_bf16_f32 v71, v54, v55
  s_waitcnt vmcnt(4) lgkmcnt(0)
  s_nop 0
  v_mfma_f32_32x32x16_bf16 v[72:87], v[68:71], v[192:195], v[72:87]
  v_add_f32 v40, 0x358637bd, v40
  v_rcp_f32_e64 v40, v40
  ds_read_b128 v[28:31], v15 offset:7616
  v_mul_f32 v32, v32, v40
  v_mul_f32 v33, v33, v40
  v_mfma_f32_32x32x16_bf16 v[48:63], v[24:27], a[244:247], 0
  v_mul_f32 v34, v34, v40
  v_mul_f32 v35, v35, v40
  v_mul_f32 v36, v36, v40
  v_mul_f32 v37, v37, v40
  v_mul_f32 v38, v38, v40
  v_mul_f32 v39, v39, v40
  v_mfma_f32_32x32x16_bf16 v[88:103], v[68:71], v[196:199], v[88:103]
  v_cvt_pk_bf16_f32 v64, v32, v33
  v_cvt_pk_bf16_f32 v65, v34, v35
  v_cvt_pk_bf16_f32 v66, v36, v37
  v_cvt_pk_bf16_f32 v67, v38, v39
  s_waitcnt vmcnt(3) lgkmcnt(0)
  s_nop 0
  v_mfma_f32_32x32x16_bf16 v[72:87], v[64:67], v[200:203], v[72:87]
  v_add_f32 v56, 0x358637bd, v56
  v_rcp_f32_e64 v56, v56
  ds_read_b128 v[20:23], v15 offset:8160
  v_mul_f32 v48, v48, v56
  v_mul_f32 v49, v49, v56
  v_mfma_f32_32x32x16_bf16 v[32:47], v[28:31], a[248:251], 0
  v_mul_f32 v50, v50, v56
  v_mul_f32 v51, v51, v56
  v_mul_f32 v52, v52, v56
  v_mul_f32 v53, v53, v56
  v_mul_f32 v54, v54, v56
  v_mul_f32 v55, v55, v56
  v_mfma_f32_32x32x16_bf16 v[88:103], v[64:67], v[204:207], v[88:103]
  v_cvt_pk_bf16_f32 v68, v48, v49
  v_cvt_pk_bf16_f32 v69, v50, v51
  v_cvt_pk_bf16_f32 v70, v52, v53
  v_cvt_pk_bf16_f32 v71, v54, v55
  s_waitcnt vmcnt(2) lgkmcnt(0)
  s_nop 0
  v_mfma_f32_32x32x16_bf16 v[72:87], v[68:71], v[208:211], v[72:87]
  v_add_f32 v40, 0x358637bd, v40
  v_rcp_f32 v40, v40
  s_nop 0
  v_mul_f32 v32, v32, v40
  v_mul_f32 v33, v33, v40
  v_mfma_f32_32x32x16_bf16 v[48:63], v[20:23], a[252:255], 0
  v_mul_f32 v34, v34, v40
  v_mul_f32 v35, v35, v40
  v_mul_f32 v36, v36, v40
  v_mul_f32 v37, v37, v40
  v_mul_f32 v38, v38, v40
  v_mul_f32 v39, v39, v40
  v_mfma_f32_32x32x16_bf16 v[88:103], v[68:71], v[212:215], v[88:103]
  v_cvt_pk_bf16_f32 v64, v32, v33
  v_cvt_pk_bf16_f32 v65, v34, v35
  v_cvt_pk_bf16_f32 v66, v36, v37
  v_cvt_pk_bf16_f32 v67, v38, v39
  s_nop 1
  v_mfma_f32_32x32x16_bf16 v[72:87], v[64:67], v[216:219], v[72:87]
  v_add_f32 v56, 0x358637bd, v56
  v_rcp_f32 v56, v56
  s_nop 0
  v_mul_f32 v48, v48, v56
  v_mul_f32 v49, v49, v56
  v_mul_f32 v50, v50, v56
  v_mul_f32 v51, v51, v56
  v_mul_f32 v52, v52, v56
  v_mul_f32 v53, v53, v56
  v_mul_f32 v54, v54, v56
  v_mul_f32_e64 v55, v55, v56
  v_mfma_f32_32x32x16_bf16 v[88:103], v[64:67], v[220:223], v[88:103]
  v_cvt_pk_bf16_f32 v68, v48, v49
  v_cvt_pk_bf16_f32 v69, v50, v51
  v_cvt_pk_bf16_f32 v70, v52, v53
  v_cvt_pk_bf16_f32 v71, v54, v55
  s_nop 1
  v_mfma_f32_32x32x16_bf16 v[72:87], v[68:71], v[224:227], v[72:87]
  v_mfma_f32_32x32x16_bf16 v[88:103], v[68:71], v[228:231], v[88:103]
  s_nop 10
  ds_write_b128 v16, v[72:75] offset:0
  ds_write_b128 v16, v[76:79] offset:32
  ds_write_b128 v16, v[80:83] offset:64
  ds_write_b128 v16, v[84:87] offset:96
  ds_write_b128 v16, v[88:91] offset:8704
  ds_write_b128 v16, v[92:95] offset:8736
  ds_write_b128 v16, v[96:99] offset:8768
  ds_write_b128 v16, v[100:103] offset:8800
  s_waitcnt lgkmcnt(0)
  s_barrier
  ds_read_b128 v[32:35], v17 offset:0
  ds_read_b128 v[36:39], v17 offset:16
  ds_read_b128 v[40:43], v17 offset:17408
  ds_read_b128 v[44:47], v17 offset:17424
  ds_read_b128 v[48:51], v17 offset:8704
  ds_read_b128 v[52:55], v17 offset:8720
  ds_read_b128 v[56:59], v17 offset:26112
  ds_read_b128 v[60:63], v17 offset:26128
  s_waitcnt vmcnt(0)
  v_add_u32 v8, s73, v8
  v_add_u32 v9, 0x20000, v8
  s_waitcnt lgkmcnt(4)
  s_nop 0
  v_pk_add_f32 v[32:33], v[32:33], v[40:41]
  v_pk_add_f32 v[34:35], v[34:35], v[42:43]
  v_pk_add_f32 v[36:37], v[36:37], v[44:45]
  v_pk_add_f32 v[38:39], v[38:39], v[46:47]
  v_cvt_pk_bf16_f32 v40, v32, v33
  v_cvt_pk_bf16_f32 v41, v34, v35
  v_cvt_pk_bf16_f32 v42, v36, v37
  v_cvt_pk_bf16_f32 v43, v38, v39
  v_lshlrev_b32_e64 v32, 16, v40
  v_and_b32 v33, 0xffff0000, v40
  v_lshlrev_b32_e64 v132, 16, v104
  v_and_b32 v133, 0xffff0000, v104
  v_lshlrev_b32_e64 v34, 16, v41
  v_and_b32 v35, 0xffff0000, v41
  v_lshlrev_b32_e64 v134, 16, v105
  v_and_b32 v135, 0xffff0000, v105
  v_lshlrev_b32_e64 v36, 16, v42
  v_and_b32 v37, 0xffff0000, v42
  v_lshlrev_b32_e64 v136, 16, v106
  v_and_b32 v137, 0xffff0000, v106
  v_lshlrev_b32_e64 v38, 16, v43
  v_and_b32 v39, 0xffff0000, v43
  v_lshlrev_b32_e64 v138, 16, v107
  v_and_b32 v139, 0xffff0000, v107
  v_pk_add_f32 v[32:33], v[32:33], v[132:133]
  v_pk_add_f32 v[34:35], v[34:35], v[134:135]
  v_pk_add_f32 v[36:37], v[36:37], v[136:137]
  v_pk_add_f32 v[38:39], v[38:39], v[138:139]
  v_cvt_pk_bf16_f32 v160, v32, v33
  v_cvt_pk_bf16_f32 v161, v34, v35
  v_cvt_pk_bf16_f32 v162, v36, v37
  v_cvt_pk_bf16_f32 v163, v38, v39
  ds_write_b128 v18, v[160:163] offset:0
  s_waitcnt lgkmcnt(0)
  s_nop 0
  v_pk_add_f32 v[48:49], v[48:49], v[56:57]
  v_pk_add_f32 v[50:51], v[50:51], v[58:59]
  v_pk_add_f32 v[52:53], v[52:53], v[60:61]
  v_pk_add_f32 v[54:55], v[54:55], v[62:63]
  v_cvt_pk_bf16_f32 v56, v48, v49
  v_cvt_pk_bf16_f32 v57, v50, v51
  v_cvt_pk_bf16_f32 v58, v52, v53
  v_cvt_pk_bf16_f32 v59, v54, v55
  v_lshlrev_b32_e64 v48, 16, v56
  v_and_b32 v49, 0xffff0000, v56
  v_lshlrev_b32_e64 v140, 16, v108
  v_and_b32 v141, 0xffff0000, v108
  v_lshlrev_b32_e64 v50, 16, v57
  v_and_b32 v51, 0xffff0000, v57
  v_lshlrev_b32_e64 v142, 16, v109
  v_and_b32 v143, 0xffff0000, v109
  v_lshlrev_b32_e64 v52, 16, v58
  v_and_b32 v53, 0xffff0000, v58
  v_lshlrev_b32_e64 v144, 16, v110
  v_and_b32 v145, 0xffff0000, v110
  v_lshlrev_b32_e64 v54, 16, v59
  v_and_b32 v55, 0xffff0000, v59
  v_lshlrev_b32_e64 v146, 16, v111
  v_and_b32 v147, 0xffff0000, v111
  v_pk_add_f32 v[48:49], v[48:49], v[140:141]
  v_pk_add_f32 v[50:51], v[50:51], v[142:143]
  v_pk_add_f32 v[52:53], v[52:53], v[144:145]
  v_pk_add_f32 v[54:55], v[54:55], v[146:147]
  v_cvt_pk_bf16_f32 v164, v48, v49
  v_cvt_pk_bf16_f32 v165, v50, v51
  v_cvt_pk_bf16_f32 v166, v52, v53
  v_cvt_pk_bf16_f32 v167, v54, v55
  ds_write_b128 v18, v[164:167] offset:4608
  s_cmp_eq_u32 s6, 0
  s_cbranch_scc0 FIN_52
  buffer_store_dwordx4 v[160:163], v8, s[44:47], 0 offen sc1
  buffer_store_dwordx4 v[164:167], v9, s[44:47], 0 offen sc1
FIN_52:
  v_lshrrev_b32_e64 v10, 2, v243
  v_lshl_add_u32 v10, v242, 3, v10
  v_mul_u32_u24 v10, 144, v10
  v_and_b32_e64 v11, 3, v243
  v_lshl_add_u32 v10, v11, 3, v10
  s_lshl_b32 s8, s3, 5
  s_add_u32 s8, s8, 134656
  v_add_u32 v10, s8, v10
  s_waitcnt lgkmcnt(0)
  s_barrier
  ds_read_b64_tr_b16 v[104:105], v10
  ds_read_b64_tr_b16 v[106:107], v10 offset:576
  ds_read_b64_tr_b16 v[108:109], v10 offset:4608
  ds_read_b64_tr_b16 v[110:111], v10 offset:5184
  s_cmp_eq_u32 s6, 0
  s_cbranch_scc0 OE_53
  s_lshl_b32 s8, s4, 7
  s_lshl_b32 s9, s3, 5
  s_add_u32 s8, s8, s9
  s_add_u32 s8, s8, 327680
  v_bfe_u32 v11, v243, 1, 2
  v_lshlrev_b32 v11, 12, v11
  v_lshrrev_b32_e64 v12, 3, v243
  v_lshl_add_u32 v11, v12, 4, v11
  v_and_b32_e64 v12, 1, v243
  v_lshl_add_u32 v11, v12, 3, v11
  v_lshl_add_u32 v11, v242, 2, v11
  v_add_u32 v11, s8, v11
  v_mov_b32 v112, 0
  v_mov_b32 v113, 0
  v_mov_b32 v114, 0
  v_mov_b32 v115, 0
  s_waitcnt lgkmcnt(0)
  v_dot2_f32_bf16 v112, v104, s64, v112
  v_dot2_f32_bf16 v113, v104, v104, v113
  v_dot2_f32_bf16 v114, v108, s64, v114
  v_dot2_f32_bf16 v115, v108, v108, v115
  v_dot2_f32_bf16 v112, v105, s64, v112
  v_dot2_f32_bf16 v113, v105, v105, v113
  v_dot2_f32_bf16 v114, v109, s64, v114
  v_dot2_f32_bf16 v115, v109, v109, v115
  v_dot2_f32_bf16 v112, v106, s64, v112
  v_dot2_f32_bf16 v113, v106, v106, v113
  v_dot2_f32_bf16 v114, v110, s64, v114
  v_dot2_f32_bf16 v115, v110, v110, v115
  v_dot2_f32_bf16 v112, v107, s64, v112
  v_dot2_f32_bf16 v113, v107, v107, v113
  v_dot2_f32_bf16 v114, v111, s64, v114
  v_dot2_f32_bf16 v115, v111, v111, v115
  s_nop 2
  v_pk_add_f32 v[112:113], v[112:113], v[114:115]
  v_mov_b32 v116, v112
  v_mov_b32 v117, v113
  s_nop 0
  v_permlane16_swap_b32 v112, v116
  v_permlane16_swap_b32 v113, v117
  v_add_f32 v112, v112, v116
  v_add_f32 v113, v113, v117
  v_mov_b32 v116, v112
  v_mov_b32 v117, v113
  s_nop 0
  v_permlane32_swap_b32 v112, v116
  v_permlane32_swap_b32 v113, v117
  v_add_f32 v112, v112, v116
  v_add_f32 v113, v113, v117
  v_cmp_eq_u32 vcc, 0, v242
  s_nop 1
  v_cndmask_b32 v112, v113, v112, vcc
  s_mov_b64 exec, 0xffffffff
  buffer_atomic_add_f32 v112, v11, s[44:47], 0 offen
  s_mov_b64 exec, -1
  s_branch OX_54
OE_53:
  s_lshl_b32 s8, s4, 16
  s_lshl_b32 s9, s3, 14
  s_add_u32 s8, s8, s9
  s_lshl_b32 s9, s5, 7
  s_add_u32 s8, s8, s9
  v_lshlrev_b32 v11, 10, v243
  v_lshl_add_u32 v11, v242, 4, v11
  v_add_u32 v11, s8, v11
  s_waitcnt lgkmcnt(0)
  buffer_store_dwordx4 v[104:107], v11, s[56:59], 0 offen
  buffer_store_dwordx4 v[108:111], v11, s[56:59], 0 offen offset:64
OX_54:
  s_cmp_eq_u32 s6, 1
  s_cbranch_scc1 L_END
  s_waitcnt vmcnt(0) lgkmcnt(0)
  s_barrier
  s_add_u32 s7, s7, 16
  s_cmp_eq_u32 s3, 0
  s_cbranch_scc0 ARR_55
  s_mov_b64 exec, 1
  v_mov_b32_e64 v232, 1
  buffer_atomic_add v232, v239, s[44:47], 0 offen sc0 sc1
  s_mov_b64 exec, -1
ARR_55:
  s_mov_b32 s6, 1
  s_branch L_LAYER
L_END:
L_EXIT:
  s_endpgm
.section .rodata,"a"
.p2align 6
.amdhsa_kernel interleave_layers__ssm_conv_s4d__linear_attn_block__prompt_kernel
  .amdhsa_next_free_vgpr 512
  .amdhsa_next_free_sgpr 102
  .amdhsa_accum_offset 256
  .amdhsa_group_segment_fixed_size 0
  .amdhsa_kernarg_size 104
  .amdhsa_user_sgpr_count 2
  .amdhsa_user_sgpr_kernarg_segment_ptr 1
  .amdhsa_system_sgpr_workgroup_id_x 1
.end_amdhsa_kernel
```
